```python
import torch

def _softmax(x, axis=-1):
    return torch.softmax(x, dim=axis)
def _gelu(x):
    return torch.nn.functional.gelu(x, approximate="tanh")
def _silu(x):
    return torch.nn.functional.silu(x)
def _sigmoid(x):
    return torch.sigmoid(x)
def _layernorm(x, axis=-1, eps=1e-5):
    m = x.mean(dim=axis, keepdim=True)
    v = x.var(dim=axis, keepdim=True, unbiased=False)
    return (x - m) / torch.sqrt(v + eps)
def _scatter_add(tgt, idx, src, axis=0):
    return tgt.clone().index_add_(axis, idx, src)
def _segment_sum(src, seg, n):
    out = torch.zeros((n,) + src.shape[1:], dtype=src.dtype)
    return out.index_add_(0, seg, src)
def _pad(x, pw):
    flat = tuple(v for pair in reversed(pw) for v in pair)
    return torch.nn.functional.pad(x, flat)

kernel_name = 'gated_mix__ssm_conv_s4d__mixer_channel_mlp__prompt'

def setup_inputs():

    _w = (lambda a: (lambda t: t.to(torch.bfloat16) if t.is_floating_point() else t)(torch.as_tensor(a)))
    def _A_setup():
        Bsz, L, D, N = 1, 2048, 512, 128
        return {
            "u": _w((lambda *s: torch.randn(*s, dtype=torch.bfloat16) * 0.05)(Bsz, L, D)),
            "log_A_real": _w((lambda *s: torch.randn(*s, dtype=torch.bfloat16) * 3.2)(D, N) * 0.5),
            "A_imag": _w((lambda *s: torch.randn(*s, dtype=torch.bfloat16) * 0.1)(D, N) * 3.14),
            "C_real": _w((lambda *s: torch.randn(*s, dtype=torch.bfloat16) * 0.8)(D, N) / N ** 0.5),
            "C_imag": _w((lambda *s: torch.randn(*s, dtype=torch.bfloat16) * 0.8)(D, N) / N ** 0.5),
            "log_dt": _w((lambda *s: torch.randn(*s, dtype=torch.bfloat16) * 0.1)(D) * 0.5 - 4.0),
            "D_skip": _w((lambda *s: torch.randn(*s, dtype=torch.bfloat16) * 0.1)(D)),
        }
    _A_in = _A_setup()

    def _B_setup():
        B, S, D, F = 1, 2048, 512, 1792
        return {
            "x": _w((lambda *s: torch.randn(*s, dtype=torch.bfloat16) * 0.05)(B, S, D)),
            "w1": _w((lambda *s: torch.randn(*s, dtype=torch.bfloat16) * 0.8)(D, F) * (D ** -0.5)),
            "b1": _w((lambda *s: torch.randn(*s, dtype=torch.bfloat16) * 0.4)(F)),
            "w2": _w((lambda *s: torch.randn(*s, dtype=torch.bfloat16) * 0.05)(F, D) * (F ** -0.5)),
            "b2": _w((lambda *s: torch.randn(*s, dtype=torch.bfloat16) * 0.05)(D)),
        }
    _B_in = _B_setup()

    return {
        "A_u": _A_in["u"],
        "A_log_A_real": _A_in["log_A_real"],
        "A_A_imag": _A_in["A_imag"],
        "A_C_real": _A_in["C_real"],
        "A_C_imag": _A_in["C_imag"],
        "A_log_dt": _A_in["log_dt"],
        "A_D_skip": _A_in["D_skip"],
        "B_x": _B_in["x"],
        "B_w1": _B_in["w1"],
        "B_b1": _B_in["b1"],
        "B_w2": _B_in["w2"],
        "B_b2": _B_in["b2"],
        "gate_w": _w((lambda *s: torch.randn(*s, dtype=torch.bfloat16) * 0.05)(512) * 16.0),
    }

def reference(A_u, A_log_A_real, A_A_imag, A_C_real, A_C_imag, A_log_dt, A_D_skip, B_x, B_w1, B_b1, B_w2, B_b2, gate_w):
    def _A_ref(u, log_A_real, A_imag, C_real, C_imag, log_dt, D_skip):
        L = u.shape[1]
        dt = torch.exp(log_dt)
        A = -torch.exp(log_A_real) + 1j * A_imag
        C = (C_real + 1j * C_imag) * dt[:, None]
        pos = (lambda x, dt: x.to(dt))(torch.arange(L), log_dt.dtype)
        P = torch.exp((A * dt[:, None])[:, :, None] * pos[None, None, :])
        K = 2.0 * torch.einsum("dn,dnl->dl", C, P).real
        L2 = 2 * L
        u_t = (lambda x, *d: x.permute(*d))(u, 0, 2, 1)
        Kf = (lambda x, *a, **k: torch.fft.rfft(x.float(), *a, **k))(K, L2)
        Uf = (lambda x, *a, **k: torch.fft.rfft(x.float(), *a, **k))(u_t, L2)
        y = (lambda x, *a, **k: torch.fft.irfft(x, *a, **k).to(torch.bfloat16))(Uf * Kf[None, :, :], L2)[:, :, :L]
        y = (lambda x, *d: x.permute(*d))(y, 0, 2, 1)
        return y + u * D_skip[None, None, :]

    def _B_ref(x, w1, b1, w2, b2):
        y = _layernorm(x, axis=-1)
        h = _gelu(torch.einsum("bsd,df->bsf", y, w1) + b1)
        return torch.einsum("bsf,fd->bsd", h, w2) + b2

    x = A_u
    g = _sigmoid((x * gate_w).sum(-1, keepdims=True))
    a = _A_ref(x, A_log_A_real, A_A_imag, A_C_real, A_C_imag, A_log_dt, A_D_skip)
    b = _B_ref(x, B_w1, B_b1, B_w2, B_b2)
    return g * a + (1 - g) * b
```

```asm
; @launch grid=(256,1,1) block=(256,1,1) lds=163840
.amdgcn_target "amdgcn-amd-amdhsa--gfx950"
.text
.p2align 12
.fill 832, 4, 0xbf810000
.globl gated_mix__ssm_conv_s4d__mixer_channel_mlp__prompt_kernel
.p2align 8
.type gated_mix__ssm_conv_s4d__mixer_channel_mlp__prompt_kernel,@function
gated_mix__ssm_conv_s4d__mixer_channel_mlp__prompt_kernel:
    s_cmp_ge_u32 s2, 0x100
    s_cbranch_scc1 Lend
    s_load_dwordx2 s[36:37], s[0:1], 0
    s_load_dwordx2 s[40:41], s[0:1], 64
    s_load_dwordx16 s[4:19], s[0:1], 0
    s_load_dwordx16 s[20:35], s[0:1], 64
    s_getpc_b64 s[62:63]
Lpc:
    s_cmp_ge_u32 s2, 224
    s_cbranch_scc1 Lspare
    s_cmp_lg_u32 s2, 0
    s_cbranch_scc1 Lback_clk
    s_memrealtime s[72:73]
Lback_clk:
    v_lshrrev_b32 v8, 6, v0
    v_and_b32 v1, 63, v0
    v_readfirstlane_b32 s58, v8
    v_mov_b32 v2, 0
    s_and_b32 s56, s2, 7
    s_lshr_b32 s57, s2, 3
    s_lshl2_add_u32 s60, s57, s58
    s_mul_i32 s60, s60, 384
    v_and_b32 v9, 3, v1
    v_lshl_add_u32 v9, v9, 7, s60
    v_min_u32 v9, Lcode_end-Lpc-4, v9
    global_load_dword v7, v9, s[62:63]
    s_lshl_b32 s60, s2, 9
    v_lshl_add_u32 v47, v0, 1, s60
    s_lshl_b32 s79, s2, 2
    v_lshlrev_b32 v20, 4, v1
    v_and_b32 v4, 15, v1
    v_lshrrev_b32 v5, 4, v1
    s_mov_b32 s38, 0x200000
    s_mov_b32 s39, 0x20000
    s_mov_b32 s42, 1835008
    s_mov_b32 s43, 0x20000
    s_lshl_b32 s66, s58, 12
    s_lshl_b32 s78, s58, 13
    s_lshl_b32 s91, s58, 11
    s_and_b32 s59, s58, 1
    s_lshr_b32 s60, s56, 1
    s_and_b32 s61, s57, 7
    s_lshl3_add_u32 s98, s60, s61
    s_and_b32 s60, s56, 1
    s_lshr_b32 s61, s57, 3
    s_lshl2_add_u32 s99, s60, s61
    s_lshl2_add_u32 s3, s98, s58
    s_lshl_b32 s3, s3, 7
    s_add_u32 s3, s3, s99
    s_lshl_b32 s3, s3, 7
    s_lshl_b32 s60, s58, 1
    v_and_b32 v10, 7, v1
    v_xor_b32 v10, s60, v10
    v_lshrrev_b32 v11, 3, v1
    v_lshlrev_b32 v11, 10, v11
    v_lshl_add_u32 v37, v10, 4, v11
    v_xor_b32 v38, 16, v37
    v_add_u32 v38, 7168, v38
    s_mul_i32 s60, s57, 9363
    s_lshr_b32 s60, s60, 16
    s_mul_i32 s61, s60, 7
    s_sub_u32 s61, s57, s61
    s_lshl2_add_u32 s80, s56, s60
    s_cmp_ge_u32 s61, 3
    s_addc_u32 s81, s61, 0
    s_lshr_b32 s62, s56, 1
    s_and_b32 s63, s56, 1
    s_lshl2_add_u32 s60, s62, s60
    s_lshl1_add_u32 s69, s63, s62
    s_mul_i32 s63, s63, 7
    s_add_u32 s61, s61, s63
    s_and_b32 s67, s60, 0
    s_lshl1_add_u32 s69, s69, s67
    s_lshl_b32 s69, s69, 3
    s_and_b32 s69, s69, 63
    s_lshr_b32 s63, s58, 1
    s_lshl1_add_u32 s75, s60, s59
    s_lshl1_add_u32 s76, s61, s63
    s_lshl2_add_u32 s67, s60, s58
    s_lshl_b32 s67, s67, 15
    s_mul_i32 s68, s58, 57344
    s_lshl_b32 s61, s61, 8
    s_add_u32 s68, s68, s61
    v_and_b32 v9, 7, v1
    v_xor_b32 v8, v5, v9
    v_lshrrev_b32 v9, 3, v1
    v_lshlrev_b32 v9, 10, v9
    v_lshl_add_u32 v49, v8, 4, v9
    v_xor_b32 v8, 64, v49
    v_add_u32 v50, 7168, v8
    v_add_u32 v51, 14336, v49
    v_add_u32 v52, 21504, v8
    v_lshlrev_b32 v8, 2, v5
    v_xor_b32 v8, v8, v4
    v_mul_u32_u24 v9, 3584, v5
    v_lshl_add_u32 v53, v8, 4, v9
    v_add_u32 v54, 13312, v53
    v_xor_b32 v8, 2, v8
    v_lshl_add_u32 v8, v8, 4, v9
    v_add_u32 v55, 26624, v8
    v_add_u32 v56, 39936, v8
    s_or_b32 s83, s2, s58
    s_waitcnt lgkmcnt(0)
    s_or_b32 s72, s72, 1
    s_cmp_lg_u32 s83, 0
    s_cbranch_scc1 Lback_nonce
    s_atomic_swap s72, s[32:33], 0
Lback_nonce:
    global_load_ushort v41, v47, s[6:7]
    global_load_ushort v42, v47, s[8:9]
    global_load_ushort v43, v47, s[10:11]
    s_add_u32 m0, s91, 147456
    global_load_ushort v44, v47, s[12:13]
    buffer_load_dwordx4 v37, s[36:39], s3 offen offset:0 lds
    buffer_load_dwordx4 v38, s[36:39], s3 offen offset:1024 lds
    s_load_dword s96, s[14:15], s79
    s_load_dword s97, s[16:17], s79
    s_add_u32 m0, s66, 32768
    s_lshl4_add_u32 s70, s69, s67
    buffer_load_dwordx4 v49, s[36:39], s70 offen offset:0 lds
    buffer_load_dwordx4 v50, s[36:39], s70 offen offset:1024 lds
    buffer_load_dwordx4 v51, s[36:39], s70 offen offset:2048 lds
    buffer_load_dwordx4 v52, s[36:39], s70 offen offset:3072 lds
    s_mul_i32 s71, s69, 28672
    s_add_u32 m0, s66, 98304
    s_add_u32 s71, s71, s68
    buffer_load_dwordx4 v53, s[40:43], s71 offen offset:0 lds
    v_lshrrev_b32 v9, 1, v4
    v_xor_b32 v9, v9, v5
    s_lshl_b32 s60, s59, 13
    s_add_u32 s60, s60, 32768
    v_lshl_add_u32 v8, v4, 7, s60
    v_lshl_add_u32 v76, v9, 4, v8
    v_xor_b32 v77, 64, v76
    v_bfe_u32 v8, v1, 2, 2
    v_lshl_add_u32 v9, v5, 3, v8
    v_lshlrev_b32 v9, 8, v9
    v_and_b32 v10, 3, v1
    v_lshl_add_u32 v9, v10, 3, v9
    buffer_load_dwordx4 v54, s[40:43], s71 offen offset:1024 lds
    s_add_u32 s69, s69, 8
    v_add_u32 v9, 98304, v9
    v_and_b32 v10, 1, v5
    v_lshl_add_u32 v8, v8, 1, v10
    s_and_b32 s60, s58, 2
    s_lshl_b32 s60, s60, 1
    v_xor_b32 v8, s60, v8
    v_lshl_add_u32 v78, v8, 5, v9
    v_xor_b32 v79, 32, v78
    v_xor_b32 v80, 64, v78
    v_xor_b32 v81, 96, v78
    v_mul_u32_u24 v8, 272, v4
    v_lshl_add_u32 v8, v5, 4, v8
    buffer_load_dwordx4 v55, s[40:43], s71 offen offset:2048 lds
    s_and_b32 s69, s69, 63
    v_add_u32 v72, s78, v8
    v_lshlrev_b32 v12, 3, v0
    s_movk_i32 s63, 128
    v_sub_u32 v58, 2047, v12
    v_cvt_f32_u32 v13, v58
    v_cvt_pk_bf16_f32 v13, v13, v2
    v_add_u32 v13, -17024, v13
    v_med3_i32 v58, v13, v58, s63
    v_and_b32 v13, 7, v58
    v_ashrrev_i32 v58, 3, v58
    v_mul_u32_u24 v13, 400, v13
    v_lshl_add_u32 v58, v58, 2, v13
    buffer_load_dwordx4 v56, s[40:43], s71 offen offset:3072 lds
    v_sub_u32 v59, 2046, v12
    v_cvt_f32_u32 v13, v59
    v_cvt_pk_bf16_f32 v13, v13, v2
    v_add_u32 v13, -17024, v13
    v_med3_i32 v59, v13, v59, s63
    v_and_b32 v13, 7, v59
    v_ashrrev_i32 v59, 3, v59
    v_mul_u32_u24 v13, 400, v13
    v_lshl_add_u32 v59, v59, 2, v13
    v_sub_u32 v60, 2045, v12
    v_cvt_f32_u32 v13, v60
    v_cvt_pk_bf16_f32 v13, v13, v2
    s_add_u32 m0, s66, 49152
    s_lshl4_add_u32 s70, s69, s67
    buffer_load_dwordx4 v49, s[36:39], s70 offen offset:0 lds
    v_add_u32 v13, -17024, v13
    v_med3_i32 v60, v13, v60, s63
    v_and_b32 v13, 7, v60
    v_ashrrev_i32 v60, 3, v60
    v_mul_u32_u24 v13, 400, v13
    v_lshl_add_u32 v60, v60, 2, v13
    v_sub_u32 v61, 2044, v12
    v_cvt_f32_u32 v13, v61
    v_cvt_pk_bf16_f32 v13, v13, v2
    v_add_u32 v13, -17024, v13
    v_med3_i32 v61, v13, v61, s63
    v_and_b32 v13, 7, v61
    v_ashrrev_i32 v61, 3, v61
    v_mul_u32_u24 v13, 400, v13
    v_lshl_add_u32 v61, v61, 2, v13
    v_sub_u32 v62, 2043, v12
    v_cvt_f32_u32 v13, v62
    v_cvt_pk_bf16_f32 v13, v13, v2
    v_add_u32 v13, -17024, v13
    v_med3_i32 v62, v13, v62, s63
    v_and_b32 v13, 7, v62
    v_ashrrev_i32 v62, 3, v62
    v_mul_u32_u24 v13, 400, v13
    v_lshl_add_u32 v62, v62, 2, v13
    v_sub_u32 v63, 2042, v12
    v_cvt_f32_u32 v13, v63
    v_cvt_pk_bf16_f32 v13, v13, v2
    v_add_u32 v13, -17024, v13
    v_med3_i32 v63, v13, v63, s63
    v_and_b32 v13, 7, v63
    v_ashrrev_i32 v63, 3, v63
    v_mul_u32_u24 v13, 400, v13
    v_lshl_add_u32 v63, v63, 2, v13
    v_sub_u32 v64, 2041, v12
    v_cvt_f32_u32 v13, v64
    v_cvt_pk_bf16_f32 v13, v13, v2
    v_add_u32 v13, -17024, v13
    v_med3_i32 v64, v13, v64, s63
    v_and_b32 v13, 7, v64
    v_ashrrev_i32 v64, 3, v64
    v_mul_u32_u24 v13, 400, v13
    v_lshl_add_u32 v64, v64, 2, v13
    v_sub_u32 v65, 2040, v12
    v_cvt_f32_u32 v13, v65
    v_cvt_pk_bf16_f32 v13, v13, v2
    v_add_u32 v13, -17024, v13
    v_med3_i32 v65, v13, v65, s63
    v_and_b32 v13, 7, v65
    v_ashrrev_i32 v65, 3, v65
    v_mul_u32_u24 v13, 400, v13
    v_lshl_add_u32 v65, v65, 2, v13
    v_sub_u32 v66, 2039, v12
    v_max_i32 v13, 0, v66
    v_cvt_f32_u32 v13, v13
    v_cvt_pk_bf16_f32 v13, v13, v2
    v_add_u32 v13, -17024, v13
    v_med3_i32 v66, v13, v66, s63
    v_and_b32 v13, 7, v66
    v_ashrrev_i32 v66, 3, v66
    v_mul_u32_u24 v13, 400, v13
    v_lshl_add_u32 v66, v66, 2, v13
    v_and_b32 v8, 7, v1
    v_lshrrev_b32 v9, 5, v1
    v_lshl_add_u32 v9, s58, 1, v9
    v_xor_b32 v9, v9, v8
    v_lshlrev_b32 v9, 4, v9
    v_lshl_add_u32 v9, v8, 10, v9
    v_bfe_u32 v10, v1, 3, 2
    v_lshl_add_u32 v9, v10, 2, v9
    v_add_u32 v39, 147456, v9
    v_lshrrev_b32 v9, 3, v1
    v_lshlrev_b32 v9, 13, v9
    v_lshl_add_u32 v40, v8, 4, v9
    s_lshl2_add_u32 s60, s99, s58
    s_lshl_b32 s60, s60, 9
    s_lshl_b32 s99, s99, 5
    s_add_u32 s99, s99, s98
    s_lshl_b32 s99, s99, 4
    s_add_u32 s99, s99, 65536
    s_add_u32 s98, s98, s60
    s_lshl_b32 s98, s98, 7
    s_add_u32 s98, s98, 2097152
    s_add_u32 s3, s98, 4096
    s_mov_b32 s18, 0x05040100
    s_mov_b32 s19, 0x07060302
    s_mov_b64 s[44:45], s[24:25]
    s_mov_b32 s46, 1835008
    s_mov_b32 s47, 0x20000
    s_mov_b64 s[48:49], s[34:35]
    s_mov_b32 s50, 268435456
    s_mov_b32 s51, 0x20000
    s_mov_b64 s[52:53], s[30:31]
    s_mov_b32 s54, 2097152
    s_mov_b32 s55, 0x20000
    s_lshl2_add_u32 s61, s2, s58
    s_mul_i32 s61, s61, 1792
    v_lshlrev_b32 v15, 7, v4
    s_lshl2_add_u32 s62, s57, s58
    s_mul_i32 s62, s62, 14336
    v_min_u32 v57, 13, v1
    v_lshlrev_b32 v57, 10, v57
    s_mov_b32 s0, 0
    s_mov_b64 exec, 0
    s_cmp_eq_u32 s58, 0
    s_cbranch_scc1 Lpg0
    s_cmp_eq_u32 s58, 1
    s_cbranch_scc1 Lpg1
    s_cmp_eq_u32 s58, 2
    s_cbranch_scc1 Lpg2
    s_branch Lpg3
Liw_ret:
    s_cmp_eq_u32 s0, 1
    s_cbranch_scc1 Liw_ret_spare
    s_mov_b64 exec, -1
    s_lshr_b32 s60, s58, 1
    s_lshl_b32 s60, s60, 4
    s_waitcnt lgkmcnt(0)
    s_lshr_b32 s96, s96, s60
    s_lshr_b32 s97, s97, s60
    v_lshlrev_b32 v45, 16, s96
    v_lshlrev_b32 v46, 16, s97
    s_mov_b32 s60, 0x3fb8aa3b
    s_waitcnt vmcnt(14)
    v_lshlrev_b32 v41, 16, v41
    v_mul_f32 v8, s60, v41
    v_mul_f32 v10, s60, v45
    v_fma_f32 v9, v41, s60, -v8
    v_fma_f32 v11, v45, s60, -v10
    v_exp_f32 v8, v8
    v_exp_f32 v10, v10
    v_fmamk_f32 v9, v41, 0x32a5705f, v9
    v_fmamk_f32 v11, v45, 0x32a5705f, v11
    v_mul_f32 v9, 0x3f317218, v9
    v_mul_f32 v11, 0x3f317218, v11
    v_fma_f32 v8, v8, v9, v8
    v_fma_f32 v10, v10, v11, v10
    s_waitcnt vmcnt(13)
    v_lshlrev_b32 v42, 16, v42
    s_waitcnt vmcnt(12)
    v_lshlrev_b32 v43, 16, v43
    s_waitcnt vmcnt(11)
    v_lshlrev_b32 v44, 16, v44
    v_cvt_pk_bf16_f32 v8, v8, v10
    v_and_b32 v45, 0xffff0000, v8
    v_lshlrev_b32 v41, 16, v8
    v_mul_f32 v41, v41, v45
    v_mul_f32 v42, v42, v45
    v_add_f32 v45, v45, v45
    v_mul_f32 v41, 0xbfb8aa3b, v41
    v_mul_f32 v42, 0.15915494, v42
    v_mul_f32 v178, v43, v45
    v_mul_f32 v179, v44, v45
    v_mul_f32 v8, 0x41000000, v41
    v_mul_f32 v9, 0x41000000, v42
    v_mul_f32 v10, 0x3f800000, v41
    v_mul_f32 v11, 0x3f800000, v42
    v_mul_f32 v12, 0x43000000, v41
    v_mul_f32 v13, 0x43000000, v42
    v_fract_f32 v9, v9
    v_exp_f32 v8, v8
    v_fract_f32 v11, v11
    v_exp_f32 v10, v10
    v_fract_f32 v13, v13
    v_exp_f32 v12, v12
    v_cos_f32 v82, v9
    v_sin_f32 v83, v9
    v_cos_f32 v84, v11
    v_sin_f32 v85, v11
    v_cos_f32 v180, v13
    v_sin_f32 v181, v13
    v_pk_mul_f32 v[82:83], v[82:83], v[8:9] op_sel_hi:[1,0]
    v_pk_mul_f32 v[84:85], v[84:85], v[10:11] op_sel_hi:[1,0]
    v_pk_mul_f32 v[180:181], v[180:181], v[12:13] op_sel_hi:[1,0]
    s_lshl_b32 s60, s59, 6
    s_sub_u32 s60, 64, s60
    v_cmp_eq_u32 vcc, s60, v1
    v_accvgpr_write_b32 a225, 0
    v_accvgpr_write_b32 a226, 0
    v_cndmask_b32 v46, 0, v46, vcc
    v_accvgpr_write_b32 a227, 0
    v_accvgpr_write_b32 a224, v46
    v_mov_b32 v214, 0x3f80
    v_cvt_pk_bf16_f32 v215, v82, -v83
    v_cvt_pk_bf16_f32 v216, v178, v179
    v_pk_mul_f32 v[86:87], v[82:83], v[82:83] op_sel_hi:[1,0]
    v_pk_mul_f32 v[182:183], v[180:181], v[180:181] op_sel_hi:[1,0]
    v_pk_mul_f32 v[184:185], v[178:179], v[84:85] op_sel_hi:[1,0]
    buffer_load_dword v7, v15, s[44:47], s61 offen
    v_pk_fma_f32 v[86:87], v[82:83], v[82:83], v[86:87] op_sel:[1,1,0] op_sel_hi:[0,1,1] neg_lo:[1,0,0]
    v_pk_fma_f32 v[182:183], v[180:181], v[180:181], v[182:183] op_sel:[1,1,0] op_sel_hi:[0,1,1] neg_lo:[1,0,0]
    v_pk_fma_f32 v[184:185], v[178:179], v[84:85], v[184:185] op_sel:[1,1,0] op_sel_hi:[0,1,1] neg_lo:[1,0,0]
    v_cvt_pk_bf16_f32 v217, v86, -v87
    v_cvt_pk_bf16_f32 v218, v184, v185
    v_pk_mul_f32 v[88:89], v[86:87], v[82:83] op_sel_hi:[1,0]
    v_pk_mul_f32 v[90:91], v[86:87], v[86:87] op_sel_hi:[1,0]
    v_pk_mul_f32 v[186:187], v[184:185], v[84:85] op_sel_hi:[1,0]
    v_pk_fma_f32 v[88:89], v[86:87], v[82:83], v[88:89] op_sel:[1,1,0] op_sel_hi:[0,1,1] neg_lo:[1,0,0]
    v_pk_fma_f32 v[90:91], v[86:87], v[86:87], v[90:91] op_sel:[1,1,0] op_sel_hi:[0,1,1] neg_lo:[1,0,0]
    v_pk_fma_f32 v[186:187], v[184:185], v[84:85], v[186:187] op_sel:[1,1,0] op_sel_hi:[0,1,1] neg_lo:[1,0,0]
    v_cvt_pk_bf16_f32 v219, v88, -v89
    s_waitcnt vmcnt(10)
    s_barrier
    ds_read2_b32 v[146:147], v39 offset0:0 offset1:32
    ds_read2_b32 v[148:149], v39 offset0:64 offset1:96
    ds_read2_b32 v[150:151], v39 offset0:128 offset1:160
    ds_read2_b32 v[152:153], v39 offset0:192 offset1:224
    v_cvt_pk_bf16_f32 v220, v90, -v91
    v_cvt_pk_bf16_f32 v221, v186, v187
    v_pk_mul_f32 v[92:93], v[82:83], v[90:91] op_sel_hi:[1,0]
    v_pk_mul_f32 v[94:95], v[86:87], v[90:91] op_sel_hi:[1,0]
    v_pk_mul_f32 v[188:189], v[186:187], v[84:85] op_sel_hi:[1,0]
    v_pk_fma_f32 v[92:93], v[82:83], v[90:91], v[92:93] op_sel:[1,1,0] op_sel_hi:[0,1,1] neg_lo:[1,0,0]
    v_pk_fma_f32 v[94:95], v[86:87], v[90:91], v[94:95] op_sel:[1,1,0] op_sel_hi:[0,1,1] neg_lo:[1,0,0]
    v_pk_fma_f32 v[188:189], v[186:187], v[84:85], v[188:189] op_sel:[1,1,0] op_sel_hi:[0,1,1] neg_lo:[1,0,0]
    v_cvt_pk_bf16_f32 v222, v92, -v93
    v_cvt_pk_bf16_f32 v223, v94, -v95
    v_cvt_pk_bf16_f32 v224, v188, v189
    v_pk_mul_f32 v[82:83], v[88:89], v[90:91] op_sel_hi:[1,0]
    v_pk_mul_f32 v[86:87], v[90:91], v[90:91] op_sel_hi:[1,0]
    v_pk_mul_f32 v[190:191], v[188:189], v[84:85] op_sel_hi:[1,0]
    v_pk_fma_f32 v[82:83], v[88:89], v[90:91], v[82:83] op_sel:[1,1,0] op_sel_hi:[0,1,1] neg_lo:[1,0,0]
    v_pk_fma_f32 v[86:87], v[90:91], v[90:91], v[86:87] op_sel:[1,1,0] op_sel_hi:[0,1,1] neg_lo:[1,0,0]
    v_pk_fma_f32 v[190:191], v[188:189], v[84:85], v[190:191] op_sel:[1,1,0] op_sel_hi:[0,1,1] neg_lo:[1,0,0]
    v_cvt_pk_bf16_f32 v225, v82, -v83
    v_cvt_pk_bf16_f32 v226, v86, -v87
    v_cvt_pk_bf16_f32 v227, v190, v191
    v_pk_mul_f32 v[88:89], v[92:93], v[90:91] op_sel_hi:[1,0]
    v_pk_mul_f32 v[96:97], v[94:95], v[90:91] op_sel_hi:[1,0]
    v_pk_mul_f32 v[192:193], v[190:191], v[84:85] op_sel_hi:[1,0]
    v_pk_fma_f32 v[88:89], v[92:93], v[90:91], v[88:89] op_sel:[1,1,0] op_sel_hi:[0,1,1] neg_lo:[1,0,0]
    s_waitcnt lgkmcnt(3)
    v_perm_b32 v154, v147, v146, s18
    s_waitcnt lgkmcnt(2)
    v_perm_b32 v155, v149, v148, s18
    s_waitcnt lgkmcnt(1)
    v_perm_b32 v156, v151, v150, s18
    s_waitcnt lgkmcnt(0)
    v_perm_b32 v157, v153, v152, s18
    v_perm_b32 v158, v147, v146, s19
    v_perm_b32 v159, v149, v148, s19
    v_perm_b32 v160, v151, v150, s19
    v_perm_b32 v161, v153, v152, s19
    buffer_store_dwordx4 v[154:157], v40, s[48:51], s98 offen sc1
    v_pk_fma_f32 v[96:97], v[94:95], v[90:91], v[96:97] op_sel:[1,1,0] op_sel_hi:[0,1,1] neg_lo:[1,0,0]
    v_pk_fma_f32 v[192:193], v[190:191], v[84:85], v[192:193] op_sel:[1,1,0] op_sel_hi:[0,1,1] neg_lo:[1,0,0]
    v_cvt_pk_bf16_f32 v228, v88, -v89
    v_cvt_pk_bf16_f32 v229, v96, -v97
    v_cvt_pk_bf16_f32 v230, v192, v193
    v_pk_mul_f32 v[92:93], v[82:83], v[90:91] op_sel_hi:[1,0]
    v_pk_mul_f32 v[94:95], v[86:87], v[90:91] op_sel_hi:[1,0]
    v_pk_mul_f32 v[194:195], v[192:193], v[84:85] op_sel_hi:[1,0]
    v_pk_fma_f32 v[92:93], v[82:83], v[90:91], v[92:93] op_sel:[1,1,0] op_sel_hi:[0,1,1] neg_lo:[1,0,0]
    v_pk_fma_f32 v[94:95], v[86:87], v[90:91], v[94:95] op_sel:[1,1,0] op_sel_hi:[0,1,1] neg_lo:[1,0,0]
    v_pk_fma_f32 v[194:195], v[192:193], v[84:85], v[194:195] op_sel:[1,1,0] op_sel_hi:[0,1,1] neg_lo:[1,0,0]
    v_cvt_pk_bf16_f32 v231, v92, -v93
    v_cvt_pk_bf16_f32 v232, v94, -v95
    v_cvt_pk_bf16_f32 v233, v194, v195
    v_pk_mul_f32 v[82:83], v[88:89], v[90:91] op_sel_hi:[1,0]
    v_pk_mul_f32 v[86:87], v[96:97], v[90:91] op_sel_hi:[1,0]
    buffer_store_dwordx4 v[158:161], v40, s[48:51], s3 offen sc1
    v_pk_mul_f32 v[94:95], v[92:93], v[90:91] op_sel_hi:[1,0]
    v_pk_mul_f32 v[196:197], v[194:195], v[84:85] op_sel_hi:[1,0]
    v_pk_fma_f32 v[82:83], v[88:89], v[90:91], v[82:83] op_sel:[1,1,0] op_sel_hi:[0,1,1] neg_lo:[1,0,0]
    v_pk_fma_f32 v[86:87], v[96:97], v[90:91], v[86:87] op_sel:[1,1,0] op_sel_hi:[0,1,1] neg_lo:[1,0,0]
    v_pk_fma_f32 v[94:95], v[92:93], v[90:91], v[94:95] op_sel:[1,1,0] op_sel_hi:[0,1,1] neg_lo:[1,0,0]
    v_pk_fma_f32 v[196:197], v[194:195], v[84:85], v[196:197] op_sel:[1,1,0] op_sel_hi:[0,1,1] neg_lo:[1,0,0]
    v_cvt_pk_bf16_f32 v234, v82, -v83
    v_cvt_pk_bf16_f32 v235, v86, -v87
    v_cvt_pk_bf16_f32 v236, v94, -v95
    s_mov_b32 m0, s78
    v_cvt_pk_bf16_f32 v237, v196, v197
    ds_write_addtid_b32 v214 offset:0
    ds_write_addtid_b32 v215 offset:272
    ds_write_addtid_b32 v217 offset:544
    ds_write_addtid_b32 v219 offset:816
    ds_write_addtid_b32 v220 offset:1088
    ds_write_addtid_b32 v222 offset:1360
    ds_write_addtid_b32 v223 offset:1632
    ds_write_addtid_b32 v225 offset:1904
    v_pk_mul_f32 v[198:199], v[178:179], v[180:181] op_sel_hi:[1,0]
    v_pk_mul_f32 v[200:201], v[184:185], v[180:181] op_sel_hi:[1,0]
    global_load_dword v6, v2, s[32:33] sc1
    v_pk_mul_f32 v[202:203], v[186:187], v[180:181] op_sel_hi:[1,0]
    v_pk_mul_f32 v[204:205], v[188:189], v[180:181] op_sel_hi:[1,0]
    v_pk_fma_f32 v[198:199], v[178:179], v[180:181], v[198:199] op_sel:[1,1,0] op_sel_hi:[0,1,1] neg_lo:[1,0,0]
    v_pk_fma_f32 v[200:201], v[184:185], v[180:181], v[200:201] op_sel:[1,1,0] op_sel_hi:[0,1,1] neg_lo:[1,0,0]
    ds_write_addtid_b32 v226 offset:2176
    ds_write_addtid_b32 v228 offset:2448
    ds_write_addtid_b32 v229 offset:2720
    ds_write_addtid_b32 v231 offset:2992
    ds_write_addtid_b32 v232 offset:3264
    ds_write_addtid_b32 v234 offset:3536
    ds_write_addtid_b32 v235 offset:3808
    ds_write_addtid_b32 v236 offset:4080
    v_pk_fma_f32 v[202:203], v[186:187], v[180:181], v[202:203] op_sel:[1,1,0] op_sel_hi:[0,1,1] neg_lo:[1,0,0]
    v_pk_fma_f32 v[204:205], v[188:189], v[180:181], v[204:205] op_sel:[1,1,0] op_sel_hi:[0,1,1] neg_lo:[1,0,0]
    v_cvt_pk_bf16_f32 v238, v198, v199
    v_cvt_pk_bf16_f32 v239, v200, v201
    v_cvt_pk_bf16_f32 v240, v202, v203
    v_cvt_pk_bf16_f32 v241, v204, v205
    v_pk_mul_f32 v[184:185], v[190:191], v[180:181] op_sel_hi:[1,0]
    v_pk_mul_f32 v[188:189], v[192:193], v[180:181] op_sel_hi:[1,0]
    v_pk_mul_f32 v[200:201], v[194:195], v[180:181] op_sel_hi:[1,0]
    v_pk_mul_f32 v[204:205], v[196:197], v[180:181] op_sel_hi:[1,0]
    v_pk_fma_f32 v[184:185], v[190:191], v[180:181], v[184:185] op_sel:[1,1,0] op_sel_hi:[0,1,1] neg_lo:[1,0,0]
    v_pk_fma_f32 v[188:189], v[192:193], v[180:181], v[188:189] op_sel:[1,1,0] op_sel_hi:[0,1,1] neg_lo:[1,0,0]
    v_pk_fma_f32 v[200:201], v[194:195], v[180:181], v[200:201] op_sel:[1,1,0] op_sel_hi:[0,1,1] neg_lo:[1,0,0]
    v_pk_fma_f32 v[204:205], v[196:197], v[180:181], v[204:205] op_sel:[1,1,0] op_sel_hi:[0,1,1] neg_lo:[1,0,0]
    ds_read_b128 a[160:163], v72 offset:0
    ds_read_b128 a[164:167], v72 offset:64
    ds_read_b128 a[168:171], v72 offset:128
    ds_read_b128 a[172:175], v72 offset:192
    v_cvt_pk_bf16_f32 v242, v184, v185
    v_cvt_pk_bf16_f32 v243, v188, v189
    v_cvt_pk_bf16_f32 v244, v200, v201
    v_cvt_pk_bf16_f32 v245, v204, v205
    ds_write_addtid_b32 v216 offset:0
    ds_write_addtid_b32 v218 offset:272
    ds_write_addtid_b32 v221 offset:544
    ds_write_addtid_b32 v224 offset:816
    v_pk_mul_f32 v[180:181], v[178:179], v[182:183] op_sel_hi:[1,0]
    v_pk_mul_f32 v[188:189], v[186:187], v[182:183] op_sel_hi:[1,0]
    v_pk_mul_f32 v[192:193], v[190:191], v[182:183] op_sel_hi:[1,0]
    v_pk_mul_f32 v[196:197], v[194:195], v[182:183] op_sel_hi:[1,0]
    v_pk_fma_f32 v[180:181], v[178:179], v[182:183], v[180:181] op_sel:[1,1,0] op_sel_hi:[0,1,1] neg_lo:[1,0,0]
    v_pk_fma_f32 v[188:189], v[186:187], v[182:183], v[188:189] op_sel:[1,1,0] op_sel_hi:[0,1,1] neg_lo:[1,0,0]
    v_pk_fma_f32 v[192:193], v[190:191], v[182:183], v[192:193] op_sel:[1,1,0] op_sel_hi:[0,1,1] neg_lo:[1,0,0]
    v_pk_fma_f32 v[196:197], v[194:195], v[182:183], v[196:197] op_sel:[1,1,0] op_sel_hi:[0,1,1] neg_lo:[1,0,0]
    ds_write_addtid_b32 v227 offset:1088
    ds_write_addtid_b32 v230 offset:1360
    ds_write_addtid_b32 v233 offset:1632
    ds_write_addtid_b32 v237 offset:1904
    v_cvt_pk_bf16_f32 v214, v180, v181
    v_cvt_pk_bf16_f32 v215, v188, v189
    v_cvt_pk_bf16_f32 v217, v192, v193
    v_cvt_pk_bf16_f32 v219, v196, v197
    v_pk_mul_f32 v[178:179], v[198:199], v[182:183] op_sel_hi:[1,0]
    v_pk_mul_f32 v[186:187], v[202:203], v[182:183] op_sel_hi:[1,0]
    v_pk_mul_f32 v[188:189], v[184:185], v[182:183] op_sel_hi:[1,0]
    v_pk_mul_f32 v[190:191], v[200:201], v[182:183] op_sel_hi:[1,0]
    ds_write_addtid_b32 v238 offset:2176
    ds_write_addtid_b32 v239 offset:2448
    ds_write_addtid_b32 v240 offset:2720
    ds_write_addtid_b32 v241 offset:2992
    v_pk_mul_f32 v[194:195], v[182:183], v[182:183] op_sel_hi:[1,0]
    v_pk_fma_f32 v[178:179], v[198:199], v[182:183], v[178:179] op_sel:[1,1,0] op_sel_hi:[0,1,1] neg_lo:[1,0,0]
    v_pk_fma_f32 v[186:187], v[202:203], v[182:183], v[186:187] op_sel:[1,1,0] op_sel_hi:[0,1,1] neg_lo:[1,0,0]
    v_pk_fma_f32 v[188:189], v[184:185], v[182:183], v[188:189] op_sel:[1,1,0] op_sel_hi:[0,1,1] neg_lo:[1,0,0]
    v_pk_fma_f32 v[190:191], v[200:201], v[182:183], v[190:191] op_sel:[1,1,0] op_sel_hi:[0,1,1] neg_lo:[1,0,0]
    v_pk_fma_f32 v[194:195], v[182:183], v[182:183], v[194:195] op_sel:[1,1,0] op_sel_hi:[0,1,1] neg_lo:[1,0,0]
    v_cvt_pk_bf16_f32 v220, v178, v179
    v_cvt_pk_bf16_f32 v222, v186, v187
    ds_write_addtid_b32 v242 offset:3264
    ds_write_addtid_b32 v243 offset:3536
    ds_write_addtid_b32 v244 offset:3808
    ds_write_addtid_b32 v245 offset:4080
    v_cvt_pk_bf16_f32 v223, v188, v189
    v_cvt_pk_bf16_f32 v225, v190, v191
    v_pk_mul_f32 v[184:185], v[180:181], v[182:183] op_sel_hi:[1,0]
    v_pk_mul_f32 v[186:187], v[192:193], v[182:183] op_sel_hi:[1,0]
    v_pk_mul_f32 v[190:191], v[178:179], v[182:183] op_sel_hi:[1,0]
    v_pk_mul_f32 v[196:197], v[188:189], v[182:183] op_sel_hi:[1,0]
    v_pk_fma_f32 v[184:185], v[180:181], v[182:183], v[184:185] op_sel:[1,1,0] op_sel_hi:[0,1,1] neg_lo:[1,0,0]
    v_pk_fma_f32 v[186:187], v[192:193], v[182:183], v[186:187] op_sel:[1,1,0] op_sel_hi:[0,1,1] neg_lo:[1,0,0]
    v_pk_fma_f32 v[190:191], v[178:179], v[182:183], v[190:191] op_sel:[1,1,0] op_sel_hi:[0,1,1] neg_lo:[1,0,0]
    v_pk_fma_f32 v[196:197], v[188:189], v[182:183], v[196:197] op_sel:[1,1,0] op_sel_hi:[0,1,1] neg_lo:[1,0,0]
    v_cvt_pk_bf16_f32 v226, v184, v185
    v_cvt_pk_bf16_f32 v228, v186, v187
    v_cvt_pk_bf16_f32 v229, v190, v191
    v_cvt_pk_bf16_f32 v231, v196, v197
    v_pk_mul_f32 v[198:199], v[180:181], v[194:195] op_sel_hi:[1,0]
    v_pk_mul_f32 v[200:201], v[192:193], v[194:195] op_sel_hi:[1,0]
    ds_read_b128 a[176:179], v72 offset:0
    ds_read_b128 a[180:183], v72 offset:64
    ds_read_b128 a[184:187], v72 offset:128
    ds_read_b128 a[188:191], v72 offset:192
    v_pk_mul_f32 v[202:203], v[178:179], v[194:195] op_sel_hi:[1,0]
    v_pk_mul_f32 v[204:205], v[188:189], v[194:195] op_sel_hi:[1,0]
    v_pk_fma_f32 v[198:199], v[180:181], v[194:195], v[198:199] op_sel:[1,1,0] op_sel_hi:[0,1,1] neg_lo:[1,0,0]
    v_pk_fma_f32 v[200:201], v[192:193], v[194:195], v[200:201] op_sel:[1,1,0] op_sel_hi:[0,1,1] neg_lo:[1,0,0]
    v_pk_fma_f32 v[202:203], v[178:179], v[194:195], v[202:203] op_sel:[1,1,0] op_sel_hi:[0,1,1] neg_lo:[1,0,0]
    v_pk_fma_f32 v[204:205], v[188:189], v[194:195], v[204:205] op_sel:[1,1,0] op_sel_hi:[0,1,1] neg_lo:[1,0,0]
    v_cvt_pk_bf16_f32 v232, v198, v199
    v_cvt_pk_bf16_f32 v234, v200, v201
    v_cvt_pk_bf16_f32 v235, v202, v203
    v_cvt_pk_bf16_f32 v236, v204, v205
    ds_write_addtid_b32 v214 offset:0
    ds_write_addtid_b32 v215 offset:272
    ds_write_addtid_b32 v217 offset:544
    ds_write_addtid_b32 v219 offset:816
    v_pk_mul_f32 v[178:179], v[184:185], v[194:195] op_sel_hi:[1,0]
    v_pk_mul_f32 v[180:181], v[190:191], v[194:195] op_sel_hi:[1,0]
    v_pk_mul_f32 v[182:183], v[198:199], v[194:195] op_sel_hi:[1,0]
    v_pk_mul_f32 v[186:187], v[202:203], v[194:195] op_sel_hi:[1,0]
    v_pk_fma_f32 v[178:179], v[184:185], v[194:195], v[178:179] op_sel:[1,1,0] op_sel_hi:[0,1,1] neg_lo:[1,0,0]
    v_pk_fma_f32 v[180:181], v[190:191], v[194:195], v[180:181] op_sel:[1,1,0] op_sel_hi:[0,1,1] neg_lo:[1,0,0]
    v_pk_fma_f32 v[182:183], v[198:199], v[194:195], v[182:183] op_sel:[1,1,0] op_sel_hi:[0,1,1] neg_lo:[1,0,0]
    v_pk_fma_f32 v[186:187], v[202:203], v[194:195], v[186:187] op_sel:[1,1,0] op_sel_hi:[0,1,1] neg_lo:[1,0,0]
    ds_write_addtid_b32 v220 offset:1088
    ds_write_addtid_b32 v222 offset:1360
    ds_write_addtid_b32 v223 offset:1632
    ds_write_addtid_b32 v225 offset:1904
    v_cvt_pk_bf16_f32 v216, v178, v179
    v_cvt_pk_bf16_f32 v218, v180, v181
    v_cvt_pk_bf16_f32 v221, v182, v183
    v_cvt_pk_bf16_f32 v224, v186, v187
    v_pk_mul_f32 v[184:185], v[178:179], v[194:195] op_sel_hi:[1,0]
    v_pk_mul_f32 v[188:189], v[180:181], v[194:195] op_sel_hi:[1,0]
    v_pk_mul_f32 v[190:191], v[182:183], v[194:195] op_sel_hi:[1,0]
    v_pk_mul_f32 v[192:193], v[186:187], v[194:195] op_sel_hi:[1,0]
    ds_write_addtid_b32 v226 offset:2176
    ds_write_addtid_b32 v228 offset:2448
    ds_write_addtid_b32 v229 offset:2720
    ds_write_addtid_b32 v231 offset:2992
    v_pk_fma_f32 v[184:185], v[178:179], v[194:195], v[184:185] op_sel:[1,1,0] op_sel_hi:[0,1,1] neg_lo:[1,0,0]
    v_pk_fma_f32 v[188:189], v[180:181], v[194:195], v[188:189] op_sel:[1,1,0] op_sel_hi:[0,1,1] neg_lo:[1,0,0]
    v_pk_fma_f32 v[190:191], v[182:183], v[194:195], v[190:191] op_sel:[1,1,0] op_sel_hi:[0,1,1] neg_lo:[1,0,0]
    v_pk_fma_f32 v[192:193], v[186:187], v[194:195], v[192:193] op_sel:[1,1,0] op_sel_hi:[0,1,1] neg_lo:[1,0,0]
    v_cvt_pk_bf16_f32 v227, v184, v185
    v_cvt_pk_bf16_f32 v230, v188, v189
    v_cvt_pk_bf16_f32 v233, v190, v191
    v_cvt_pk_bf16_f32 v237, v192, v193
    ds_write_addtid_b32 v232 offset:3264
    ds_write_addtid_b32 v234 offset:3536
    ds_write_addtid_b32 v235 offset:3808
    ds_write_addtid_b32 v236 offset:4080
    v_pk_mul_f32 v[178:179], v[184:185], v[194:195] op_sel_hi:[1,0]
    v_pk_fma_f32 v[178:179], v[184:185], v[194:195], v[178:179] op_sel:[1,1,0] op_sel_hi:[0,1,1] neg_lo:[1,0,0]
    v_cvt_pk_bf16_f32 v238, v178, v179
    s_add_u32 s61, s78, 4352
    v_mov_b32 v75, s61
    ds_write_addtid_b32 v216 offset:4352
    ds_write_addtid_b32 v218 offset:4624
    ds_write_addtid_b32 v221 offset:4896
    ds_write_addtid_b32 v224 offset:5168
    ds_write_addtid_b32 v227 offset:5440
Lpg0:
    s_cbranch_execz Lpg4
    s_add_u32 m0, s66, 49152
    s_nop 0
    buffer_load_dwordx4 v50, s[36:39], s70 offen offset:1024 lds
    s_mov_b32 m0, s78
    s_nop 0
    ds_write_addtid_b32 v230 offset:5712
    ds_write_addtid_b32 v233 offset:5984
    ds_write_addtid_b32 v237 offset:6256
    ds_write_addtid_b32 v238 offset:6528
    s_add_u32 m0, s66, 49152
    s_waitcnt lgkmcnt(15)
    v_mfma_f32_16x16x32_bf16 a[224:227], a[176:179], a[160:163], a[224:227]
    buffer_load_dwordx4 v51, s[36:39], s70 offen offset:2048 lds
    v_mfma_f32_16x16x32_bf16 a[224:227], a[180:183], a[164:167], a[224:227]
    v_mfma_f32_16x16x32_bf16 a[224:227], a[184:187], a[168:171], a[224:227]
    v_mfma_f32_16x16x32_bf16 a[224:227], a[188:191], a[172:175], a[224:227]
    v_lshrrev_b32 v8, 1, v5
    v_and_b32 v9, 1, v5
    v_mul_u32_u24 v9, 400, v9
    buffer_load_dwordx4 v52, s[36:39], s70 offen offset:3072 lds
    v_lshl_add_u32 v9, v8, 4, v9
    v_add_u32 v9, v9, v4
    v_lshl_add_u32 v67, v9, 2, s61
    v_add_u32 v68, 800, v67
    v_sub_u32 v9, 2, v8
    v_lshlrev_b32 v9, v9, v4
    s_mul_i32 s71, s69, 28672
    s_add_u32 m0, s66, 114688
    s_add_u32 s71, s71, s68
    buffer_load_dwordx4 v53, s[40:43], s71 offen offset:0 lds
    v_lshrrev_b32 v10, 3, v9
    v_and_b32 v9, 7, v9
    v_mul_u32_u24 v9, 100, v9
    ds_read_b128 a[192:195], v72 offset:0
    ds_read_b128 a[196:199], v72 offset:64
    ds_read_b128 a[200:203], v72 offset:128
    buffer_load_dwordx4 v54, s[40:43], s71 offen offset:1024 lds
    s_add_u32 s69, s69, 8
    ds_read_b128 a[204:207], v72 offset:192
    ds_read_b128 a[208:211], v72 offset:4352
    ds_read_b128 a[212:215], v72 offset:4416
    ds_read_b128 a[216:219], v72 offset:4480
    ds_read_b128 a[220:223], v72 offset:4544
    v_lshl_add_u32 v10, v5, 3, v10
    buffer_load_dwordx4 v55, s[40:43], s71 offen offset:2048 lds
    s_and_b32 s69, s69, 63
    v_add3_u32 v9, v9, v10, 32
    v_lshl_add_u32 v69, v9, 2, s61
    v_mul_u32_u24 v8, 784, v8
    v_sub_u32 v8, 800, v8
    v_add_u32 v70, v69, v8
    v_and_b32 v8, 7, v4
    buffer_load_dwordx4 v56, s[40:43], s71 offen offset:3072 lds
    v_mul_u32_u24 v8, 100, v8
    v_lshrrev_b32 v9, 3, v4
    v_lshl_add_u32 v9, v5, 3, v9
    v_add3_u32 v8, v8, v9, 64
    v_lshl_add_u32 v71, v8, 2, s61
    s_waitcnt lgkmcnt(7)
    v_mfma_f32_16x16x32_bf16 a[228:231], a[192:195], a[160:163], 0
    s_add_u32 m0, s66, 65536
    s_lshl4_add_u32 s70, s69, s67
    buffer_load_dwordx4 v49, s[36:39], s70 offen offset:0 lds
    s_waitcnt lgkmcnt(6)
    v_mfma_f32_16x16x32_bf16 a[228:231], a[196:199], a[164:167], a[228:231]
    s_waitcnt lgkmcnt(5)
    v_mfma_f32_16x16x32_bf16 a[228:231], a[200:203], a[168:171], a[228:231]
    s_waitcnt lgkmcnt(4)
    v_mfma_f32_16x16x32_bf16 a[228:231], a[204:207], a[172:175], a[228:231]
    s_waitcnt lgkmcnt(3)
    v_mfma_f32_16x16x32_bf16 a[232:235], a[208:211], a[160:163], 0
    s_waitcnt lgkmcnt(2)
    v_mfma_f32_16x16x32_bf16 a[232:235], a[212:215], a[164:167], a[232:235]
    s_waitcnt lgkmcnt(1)
    v_mfma_f32_16x16x32_bf16 a[232:235], a[216:219], a[168:171], a[232:235]
    buffer_load_dwordx4 v50, s[36:39], s70 offen offset:1024 lds
    s_waitcnt lgkmcnt(0)
    v_mfma_f32_16x16x32_bf16 a[232:235], a[220:223], a[172:175], a[232:235]
    v_lshlrev_b32 v73, 4, v0
    v_bfe_u32 v8, v1, 2, 2
    v_bfe_u32 v9, v1, 2, 1
    v_lshlrev_b32 v8, 13, v8
    v_lshl_add_u32 v8, v9, 7, v8
    buffer_load_dwordx4 v51, s[36:39], s70 offen offset:2048 lds
    v_and_b32 v9, 3, v1
    v_lshl_add_u32 v74, v9, 4, v8
    v_mov_b32 v16, 0
    v_mov_b32 v17, 0
    v_mov_b32 v18, 0
    v_mov_b32 v19, 0
    ds_write_b32 v75, v2 offset:2796
    ds_write2_b32 v67, a224, a225 offset0:0 offset1:100
    ds_write2_b32 v68, a226, a227 offset0:0 offset1:100
    ds_write2_b32 v69, a228, a229 offset0:0 offset1:100
    ds_write2_b32 v70, a230, a231 offset0:0 offset1:100
    ds_write2_b32 v71, a232, a233 offset0:0 offset1:2
    ds_write2_b32 v71, a234, a235 offset0:4 offset1:6
    s_waitcnt vmcnt(15)
    s_barrier
    ds_read_b64_tr_b16 a[96:97], v78 offset:0
    ds_read_b64_tr_b16 a[98:99], v78 offset:1024
    ds_read_b128 a[124:127], v76 offset:6144
    ds_read_b128 a[120:123], v76 offset:4096
    ds_read_b128 a[116:119], v76 offset:2048
    ds_read_b128 a[112:115], v76 offset:0
    ds_read_b64_tr_b16 a[100:101], v79 offset:0
    ds_read_b64_tr_b16 a[102:103], v79 offset:1024
    ds_read_b64_tr_b16 a[104:105], v80 offset:0
    ds_read_b64_tr_b16 a[106:107], v80 offset:1024
    ds_read_b64_tr_b16 a[108:109], v81 offset:0
    ds_read_b64_tr_b16 a[110:111], v81 offset:1024
    s_waitcnt lgkmcnt(6)
    v_mfma_f32_16x16x32_bf16 v[82:85], a[96:99], a[112:115], 0
    ds_read_b64_tr_b16 a[128:129], v78 offset:8192
    v_mfma_f32_16x16x32_bf16 v[98:101], a[96:99], a[116:119], 0
    ds_read_b64_tr_b16 a[130:131], v78 offset:9216
    buffer_load_dwordx4 v52, s[36:39], s70 offen offset:3072 lds
    v_mfma_f32_16x16x32_bf16 v[114:117], a[96:99], a[120:123], 0
    ds_read_b128 a[156:159], v77 offset:6144
    v_mfma_f32_16x16x32_bf16 v[130:133], a[96:99], a[124:127], 0
    ds_read_b128 a[152:155], v77 offset:4096
    s_waitcnt lgkmcnt(8)
    v_mfma_f32_16x16x32_bf16 v[134:137], a[100:103], a[124:127], 0
    ds_read_b128 a[148:151], v77 offset:2048
    v_mfma_f32_16x16x32_bf16 v[118:121], a[100:103], a[120:123], 0
    ds_read_b128 a[144:147], v77 offset:0
    s_mul_i32 s71, s69, 28672
    s_add_u32 m0, s66, 131072
    s_add_u32 s71, s71, s68
    buffer_load_dwordx4 v53, s[40:43], s71 offen offset:0 lds
    v_mfma_f32_16x16x32_bf16 v[102:105], a[100:103], a[116:119], 0
    ds_read_b64_tr_b16 a[132:133], v79 offset:8192
    v_mfma_f32_16x16x32_bf16 v[86:89], a[100:103], a[112:115], 0
    ds_read_b64_tr_b16 a[134:135], v79 offset:9216
    s_waitcnt lgkmcnt(10)
    v_mfma_f32_16x16x32_bf16 v[90:93], a[104:107], a[112:115], 0
    ds_read_b64_tr_b16 a[136:137], v80 offset:8192
    v_mfma_f32_16x16x32_bf16 v[106:109], a[104:107], a[116:119], 0
    ds_read_b64_tr_b16 a[138:139], v80 offset:9216
    buffer_load_dwordx4 v54, s[40:43], s71 offen offset:1024 lds
    s_add_u32 s69, s69, 8
    v_mfma_f32_16x16x32_bf16 v[122:125], a[104:107], a[120:123], 0
    ds_read_b64_tr_b16 a[140:141], v81 offset:8192
    v_mfma_f32_16x16x32_bf16 v[138:141], a[104:107], a[124:127], 0
    ds_read_b64_tr_b16 a[142:143], v81 offset:9216
    s_waitcnt lgkmcnt(12)
    v_mfma_f32_16x16x32_bf16 v[142:145], a[108:111], a[124:127], 0
    v_mfma_f32_16x16x32_bf16 v[126:129], a[108:111], a[120:123], 0
    buffer_load_dwordx4 v55, s[40:43], s71 offen offset:2048 lds
    s_and_b32 s69, s69, 63
    v_mfma_f32_16x16x32_bf16 v[110:113], a[108:111], a[116:119], 0
    v_mfma_f32_16x16x32_bf16 v[94:97], a[108:111], a[112:115], 0
    s_waitcnt lgkmcnt(6)
    v_mfma_f32_16x16x32_bf16 v[82:85], a[128:131], a[144:147], v[82:85]
    v_mfma_f32_16x16x32_bf16 v[98:101], a[128:131], a[148:151], v[98:101]
    buffer_load_dwordx4 v56, s[40:43], s71 offen offset:3072 lds
    v_mfma_f32_16x16x32_bf16 v[114:117], a[128:131], a[152:155], v[114:117]
    v_mfma_f32_16x16x32_bf16 v[130:133], a[128:131], a[156:159], v[130:133]
    s_waitcnt vmcnt(8) lgkmcnt(0)
    s_barrier
    v_mfma_f32_16x16x32_bf16 v[134:137], a[132:135], a[156:159], v[134:137]
    ds_read_b64_tr_b16 a[96:97], v78 offset:16384
    v_readfirstlane_b32 s64, v6
    s_nop 1
    s_cmp_eq_u32 s64, 0
    s_cbranch_scc1 Lretry1
Lback1:
    s_mov_b32 s65, s64
    v_mfma_f32_16x16x32_bf16 v[118:121], a[132:135], a[152:155], v[118:121]
    ds_read_b64_tr_b16 a[98:99], v78 offset:17408
    s_add_u32 m0, s66, 81920
    s_lshl4_add_u32 s70, s69, s67
    buffer_load_dwordx4 v49, s[36:39], s70 offen offset:0 lds
    v_mfma_f32_16x16x32_bf16 v[102:105], a[132:135], a[148:151], v[102:105]
    ds_read_b128 a[124:127], v76 offset:22528
    s_cmp_lg_u32 s58, 0
    s_cbranch_scc1 Lback2
    s_atomic_swap s64, s[34:35], s99
Lback2:
    v_mfma_f32_16x16x32_bf16 v[86:89], a[132:135], a[144:147], v[86:89]
    ds_read_b128 a[120:123], v76 offset:20480
    buffer_load_dwordx4 v50, s[36:39], s70 offen offset:1024 lds
    v_mfma_f32_16x16x32_bf16 v[90:93], a[136:139], a[144:147], v[90:93]
    ds_read_b128 a[116:119], v76 offset:18432
    s_mul_i32 s77, s58, 458752
    v_mfma_f32_16x16x32_bf16 v[106:109], a[136:139], a[148:151], v[106:109]
    ds_read_b128 a[112:115], v76 offset:16384
    buffer_load_dwordx4 v51, s[36:39], s70 offen offset:2048 lds
    v_mfma_f32_16x16x32_bf16 v[122:125], a[136:139], a[152:155], v[122:125]
    ds_read_b64_tr_b16 a[100:101], v79 offset:16384
    s_lshl_b32 s60, s81, 7
    v_mfma_f32_16x16x32_bf16 v[138:141], a[136:139], a[156:159], v[138:141]
    ds_read_b64_tr_b16 a[102:103], v79 offset:17408
    s_add_u32 s77, s77, s60
    v_mfma_f32_16x16x32_bf16 v[142:145], a[140:143], a[156:159], v[142:145]
    ds_read_b64_tr_b16 a[104:105], v80 offset:16384
    s_sub_u32 s77, s77, 32768
    v_mfma_f32_16x16x32_bf16 v[126:129], a[140:143], a[152:155], v[126:129]
    ds_read_b64_tr_b16 a[106:107], v80 offset:17408
    buffer_load_dwordx4 v52, s[36:39], s70 offen offset:3072 lds
    v_mfma_f32_16x16x32_bf16 v[110:113], a[140:143], a[148:151], v[110:113]
    ds_read_b64_tr_b16 a[108:109], v81 offset:16384
    s_lshr_b32 s60, s58, 1
    v_mfma_f32_16x16x32_bf16 v[94:97], a[140:143], a[144:147], v[94:97]
    ds_read_b64_tr_b16 a[110:111], v81 offset:17408
    s_waitcnt lgkmcnt(6)
    v_mfma_f32_16x16x32_bf16 v[82:85], a[96:99], a[112:115], v[82:85]
    ds_read_b64_tr_b16 a[128:129], v78 offset:24576
    s_lshl1_add_u32 s82, s2, s60
    v_mfma_f32_16x16x32_bf16 v[98:101], a[96:99], a[116:119], v[98:101]
    ds_read_b64_tr_b16 a[130:131], v78 offset:25600
    s_mul_i32 s71, s69, 28672
    s_add_u32 m0, s66, 147456
    s_add_u32 s71, s71, s68
    buffer_load_dwordx4 v53, s[40:43], s71 offen offset:0 lds
    v_mfma_f32_16x16x32_bf16 v[114:117], a[96:99], a[120:123], v[114:117]
    ds_read_b128 a[156:159], v77 offset:22528
    v_lshlrev_b32 v10, 1, v5
    v_mfma_f32_16x16x32_bf16 v[130:133], a[96:99], a[124:127], v[130:133]
    ds_read_b128 a[152:155], v77 offset:20480
    s_waitcnt lgkmcnt(8)
    v_mfma_f32_16x16x32_bf16 v[134:137], a[100:103], a[124:127], v[134:137]
    ds_read_b128 a[148:151], v77 offset:18432
    v_and_b32 v11, 7, v1
    v_mfma_f32_16x16x32_bf16 v[118:121], a[100:103], a[120:123], v[118:121]
    ds_read_b128 a[144:147], v77 offset:16384
    buffer_load_dwordx4 v54, s[40:43], s71 offen offset:1024 lds
    s_add_u32 s69, s69, 8
    v_mfma_f32_16x16x32_bf16 v[102:105], a[100:103], a[116:119], v[102:105]
    ds_read_b64_tr_b16 a[132:133], v79 offset:24576
    v_xor_b32 v10, v10, v11
    v_mfma_f32_16x16x32_bf16 v[86:89], a[100:103], a[112:115], v[86:89]
    ds_read_b64_tr_b16 a[134:135], v79 offset:25600
    s_waitcnt lgkmcnt(10)
    v_mfma_f32_16x16x32_bf16 v[90:93], a[104:107], a[112:115], v[90:93]
    ds_read_b64_tr_b16 a[136:137], v80 offset:24576
    v_lshrrev_b32 v11, 3, v1
    v_mfma_f32_16x16x32_bf16 v[106:109], a[104:107], a[116:119], v[106:109]
    ds_read_b64_tr_b16 a[138:139], v80 offset:25600
    buffer_load_dwordx4 v55, s[40:43], s71 offen offset:2048 lds
    s_and_b32 s69, s69, 63
    v_mfma_f32_16x16x32_bf16 v[122:125], a[104:107], a[120:123], v[122:125]
    ds_read_b64_tr_b16 a[140:141], v81 offset:24576
    v_lshlrev_b32 v11, 10, v11
    v_mfma_f32_16x16x32_bf16 v[138:141], a[104:107], a[124:127], v[138:141]
    ds_read_b64_tr_b16 a[142:143], v81 offset:25600
    v_lshl_add_u32 v25, v10, 4, v11
    s_waitcnt lgkmcnt(12)
    v_mfma_f32_16x16x32_bf16 v[142:145], a[108:111], a[124:127], v[142:145]
    ds_read2st64_b32 v[178:179], v58 offset0:17 offset1:81
    v_add_u32 v26, 7168, v25
    v_mfma_f32_16x16x32_bf16 v[126:129], a[108:111], a[120:123], v[126:129]
    buffer_load_dwordx4 v56, s[40:43], s71 offen offset:3072 lds
    ds_read2st64_b32 v[180:181], v58 offset0:49 offset1:113
    v_mfma_f32_16x16x32_bf16 v[110:113], a[108:111], a[116:119], v[110:113]
    ds_read2st64_b32 v[182:183], v59 offset0:17 offset1:81
    v_add_u32 v27, 14336, v25
    v_mfma_f32_16x16x32_bf16 v[94:97], a[108:111], a[112:115], v[94:97]
    ds_read2st64_b32 v[184:185], v59 offset0:49 offset1:113
    s_waitcnt lgkmcnt(10)
    v_mfma_f32_16x16x32_bf16 v[82:85], a[128:131], a[144:147], v[82:85]
    ds_read2st64_b32 v[186:187], v60 offset0:17 offset1:81
    v_add_u32 v28, 21504, v25
    v_mfma_f32_16x16x32_bf16 v[98:101], a[128:131], a[148:151], v[98:101]
    s_add_u32 m0, s66, 32768
    s_lshl4_add_u32 s70, s69, s67
    buffer_load_dwordx4 v49, s[36:39], s70 offen offset:0 lds
    ds_read2st64_b32 v[188:189], v60 offset0:49 offset1:113
    v_mfma_f32_16x16x32_bf16 v[114:117], a[128:131], a[152:155], v[114:117]
    v_lshrrev_b32 v10, 2, v1
    v_lshlrev_b32 v10, 7, v10
    v_mfma_f32_16x16x32_bf16 v[130:133], a[128:131], a[156:159], v[130:133]
    s_waitcnt vmcnt(9) lgkmcnt(6)
    s_barrier
    v_mfma_f32_16x16x32_bf16 v[134:137], a[132:135], a[156:159], v[134:137]
    ds_read_b64_tr_b16 a[96:97], v78 offset:32768
    v_and_b32 v11, 3, v1
    v_mfma_f32_16x16x32_bf16 v[118:121], a[132:135], a[152:155], v[118:121]
    ds_read_b64_tr_b16 a[98:99], v78 offset:33792
    buffer_load_dwordx4 v50, s[36:39], s70 offen offset:1024 lds
    v_mfma_f32_16x16x32_bf16 v[102:105], a[132:135], a[148:151], v[102:105]
    ds_read_b128 a[124:127], v76 offset:38912
    v_lshl_add_u32 v10, v11, 3, v10
    v_mfma_f32_16x16x32_bf16 v[86:89], a[132:135], a[144:147], v[86:89]
    ds_read_b128 a[120:123], v76 offset:36864
    buffer_load_dwordx4 v51, s[36:39], s70 offen offset:2048 lds
    v_mfma_f32_16x16x32_bf16 v[90:93], a[136:139], a[144:147], v[90:93]
    ds_read_b128 a[116:119], v76 offset:34816
    v_bfe_u32 v11, v1, 3, 2
    v_mfma_f32_16x16x32_bf16 v[106:109], a[136:139], a[148:151], v[106:109]
    ds_read_b128 a[112:115], v76 offset:32768
    buffer_load_dwordx4 v52, s[36:39], s70 offen offset:3072 lds
    v_mfma_f32_16x16x32_bf16 v[122:125], a[136:139], a[152:155], v[122:125]
    ds_read_b64_tr_b16 a[100:101], v79 offset:32768
    v_lshl_add_u32 v10, v11, 5, v10
    v_mfma_f32_16x16x32_bf16 v[138:141], a[136:139], a[156:159], v[138:141]
    ds_read_b64_tr_b16 a[102:103], v79 offset:33792
    s_add_u32 s60, s66, 65536
    v_mfma_f32_16x16x32_bf16 v[142:145], a[140:143], a[156:159], v[142:145]
    ds_read_b64_tr_b16 a[104:105], v80 offset:32768
    v_add_u32 v29, s60, v10
    v_mfma_f32_16x16x32_bf16 v[126:129], a[140:143], a[152:155], v[126:129]
    ds_read_b64_tr_b16 a[106:107], v80 offset:33792
    s_mul_i32 s71, s69, 28672
    s_add_u32 m0, s66, 98304
    s_add_u32 s71, s71, s68
    buffer_load_dwordx4 v53, s[40:43], s71 offen offset:0 lds
    v_mfma_f32_16x16x32_bf16 v[110:113], a[140:143], a[148:151], v[110:113]
    ds_read_b64_tr_b16 a[108:109], v81 offset:32768
    s_sub_u32 s60, s66, 32768
    v_mfma_f32_16x16x32_bf16 v[94:97], a[140:143], a[144:147], v[94:97]
    ds_read_b64_tr_b16 a[110:111], v81 offset:33792
    s_waitcnt lgkmcnt(6)
    v_mfma_f32_16x16x32_bf16 v[82:85], a[96:99], a[112:115], v[82:85]
    ds_read_b64_tr_b16 a[128:129], v78 offset:40960
    v_add_u32 v33, s60, v29
    v_mfma_f32_16x16x32_bf16 v[98:101], a[96:99], a[116:119], v[98:101]
    ds_read_b64_tr_b16 a[130:131], v78 offset:41984
    buffer_load_dwordx4 v54, s[40:43], s71 offen offset:1024 lds
    s_add_u32 s69, s69, 8
    v_mfma_f32_16x16x32_bf16 v[114:117], a[96:99], a[120:123], v[114:117]
    ds_read_b128 a[156:159], v77 offset:38912
    v_xor_b32 v30, 32, v29
    v_mfma_f32_16x16x32_bf16 v[130:133], a[96:99], a[124:127], v[130:133]
    ds_read_b128 a[152:155], v77 offset:36864
    s_waitcnt lgkmcnt(8)
    v_mfma_f32_16x16x32_bf16 v[134:137], a[100:103], a[124:127], v[134:137]
    ds_read_b128 a[148:151], v77 offset:34816
    v_add_u32 v34, s60, v30
    v_mfma_f32_16x16x32_bf16 v[118:121], a[100:103], a[120:123], v[118:121]
    ds_read_b128 a[144:147], v77 offset:32768
    buffer_load_dwordx4 v55, s[40:43], s71 offen offset:2048 lds
    s_and_b32 s69, s69, 63
    v_mfma_f32_16x16x32_bf16 v[102:105], a[100:103], a[116:119], v[102:105]
    ds_read_b64_tr_b16 a[132:133], v79 offset:40960
    v_xor_b32 v31, 64, v29
    v_mfma_f32_16x16x32_bf16 v[86:89], a[100:103], a[112:115], v[86:89]
    ds_read_b64_tr_b16 a[134:135], v79 offset:41984
    s_waitcnt lgkmcnt(10)
    v_mfma_f32_16x16x32_bf16 v[90:93], a[104:107], a[112:115], v[90:93]
    ds_read_b64_tr_b16 a[136:137], v80 offset:40960
    v_add_u32 v35, s60, v31
    v_mfma_f32_16x16x32_bf16 v[106:109], a[104:107], a[116:119], v[106:109]
    ds_read_b64_tr_b16 a[138:139], v80 offset:41984
    buffer_load_dwordx4 v56, s[40:43], s71 offen offset:3072 lds
    v_mfma_f32_16x16x32_bf16 v[122:125], a[104:107], a[120:123], v[122:125]
    ds_read_b64_tr_b16 a[140:141], v81 offset:40960
    v_xor_b32 v32, 96, v29
    v_mfma_f32_16x16x32_bf16 v[138:141], a[104:107], a[124:127], v[138:141]
    ds_read_b64_tr_b16 a[142:143], v81 offset:41984
    v_add_u32 v36, s60, v32
    s_waitcnt lgkmcnt(12)
    v_mfma_f32_16x16x32_bf16 v[142:145], a[108:111], a[124:127], v[142:145]
    ds_read2st64_b32 v[190:191], v61 offset0:17 offset1:81
    v_and_b32 v12, 1, v1
    v_mfma_f32_16x16x32_bf16 v[126:129], a[108:111], a[120:123], v[126:129]
    s_add_u32 m0, s66, 49152
    s_lshl4_add_u32 s70, s69, s67
    buffer_load_dwordx4 v49, s[36:39], s70 offen offset:0 lds
    ds_read2st64_b32 v[192:193], v61 offset0:49 offset1:113
    v_mfma_f32_16x16x32_bf16 v[110:113], a[108:111], a[116:119], v[110:113]
    ds_read2st64_b32 v[194:195], v62 offset0:17 offset1:81
    v_lshrrev_b32 v13, 1, v4
    v_mfma_f32_16x16x32_bf16 v[94:97], a[108:111], a[112:115], v[94:97]
    ds_read2st64_b32 v[196:197], v62 offset0:49 offset1:113
    s_waitcnt lgkmcnt(10)
    v_mfma_f32_16x16x32_bf16 v[82:85], a[128:131], a[144:147], v[82:85]
    ds_read2st64_b32 v[198:199], v63 offset0:17 offset1:81
    s_and_b32 s60, s58, 2
    v_mfma_f32_16x16x32_bf16 v[98:101], a[128:131], a[148:151], v[98:101]
    buffer_load_dwordx4 v50, s[36:39], s70 offen offset:1024 lds
    ds_read2st64_b32 v[200:201], v63 offset0:49 offset1:113
    v_mfma_f32_16x16x32_bf16 v[114:117], a[128:131], a[152:155], v[114:117]
    s_lshl_b32 s60, s60, 13
    s_lshl_b32 s62, s59, 8
    v_mfma_f32_16x16x32_bf16 v[130:133], a[128:131], a[156:159], v[130:133]
    s_waitcnt vmcnt(10) lgkmcnt(6)
    s_barrier
    v_mfma_f32_16x16x32_bf16 v[134:137], a[132:135], a[156:159], v[134:137]
    ds_read_b64_tr_b16 a[96:97], v78 offset:49152
    s_sub_u32 s60, s60, s62
    v_mfma_f32_16x16x32_bf16 v[118:121], a[132:135], a[152:155], v[118:121]
    ds_read_b64_tr_b16 a[98:99], v78 offset:50176
    buffer_load_dwordx4 v51, s[36:39], s70 offen offset:2048 lds
    v_mfma_f32_16x16x32_bf16 v[102:105], a[132:135], a[148:151], v[102:105]
    ds_read_b128 a[124:127], v76 offset:55296
    s_add_u32 s61, s60, 312
    v_mfma_f32_16x16x32_bf16 v[86:89], a[132:135], a[144:147], v[86:89]
    ds_read_b128 a[120:123], v76 offset:53248
    buffer_load_dwordx4 v52, s[36:39], s70 offen offset:3072 lds
    v_mfma_f32_16x16x32_bf16 v[90:93], a[136:139], a[144:147], v[90:93]
    ds_read_b128 a[116:119], v76 offset:51200
    v_mul_u32_u24 v37, 8320, v12
    v_mfma_f32_16x16x32_bf16 v[106:109], a[136:139], a[148:151], v[106:109]
    ds_read_b128 a[112:115], v76 offset:49152
    s_mul_i32 s71, s69, 28672
    s_add_u32 m0, s66, 114688
    s_add_u32 s71, s71, s68
    buffer_load_dwordx4 v53, s[40:43], s71 offen offset:0 lds
    v_mfma_f32_16x16x32_bf16 v[122:125], a[136:139], a[152:155], v[122:125]
    ds_read_b64_tr_b16 a[100:101], v79 offset:49152
    v_lshl_add_u32 v37, v5, 4, v37
    v_mfma_f32_16x16x32_bf16 v[138:141], a[136:139], a[156:159], v[138:141]
    ds_read_b64_tr_b16 a[102:103], v79 offset:50176
    v_lshlrev_b32 v14, 3, v13
    v_mfma_f32_16x16x32_bf16 v[142:145], a[140:143], a[156:159], v[142:145]
    ds_read_b64_tr_b16 a[104:105], v80 offset:49152
    v_sub_u32 v37, v37, v14
    v_mfma_f32_16x16x32_bf16 v[126:129], a[140:143], a[152:155], v[126:129]
    ds_read_b64_tr_b16 a[106:107], v80 offset:50176
    buffer_load_dwordx4 v54, s[40:43], s71 offen offset:1024 lds
    s_add_u32 s69, s69, 8
    v_mfma_f32_16x16x32_bf16 v[110:113], a[140:143], a[148:151], v[110:113]
    ds_read_b64_tr_b16 a[108:109], v81 offset:49152
    v_add_u32 v37, s61, v37
    v_mfma_f32_16x16x32_bf16 v[94:97], a[140:143], a[144:147], v[94:97]
    ds_read_b64_tr_b16 a[110:111], v81 offset:50176
    s_waitcnt lgkmcnt(6)
    v_mfma_f32_16x16x32_bf16 v[82:85], a[96:99], a[112:115], v[82:85]
    ds_read_b64_tr_b16 a[128:129], v78 offset:57344
    s_add_u32 s61, s60, 33088
    v_mfma_f32_16x16x32_bf16 v[98:101], a[96:99], a[116:119], v[98:101]
    ds_read_b64_tr_b16 a[130:131], v78 offset:58368
    buffer_load_dwordx4 v55, s[40:43], s71 offen offset:2048 lds
    s_and_b32 s69, s69, 63
    v_mfma_f32_16x16x32_bf16 v[114:117], a[96:99], a[120:123], v[114:117]
    ds_read_b128 a[156:159], v77 offset:55296
    v_mul_u32_u24 v38, 8224, v12
    v_mfma_f32_16x16x32_bf16 v[130:133], a[96:99], a[124:127], v[130:133]
    ds_read_b128 a[152:155], v77 offset:53248
    s_waitcnt lgkmcnt(8)
    v_mfma_f32_16x16x32_bf16 v[134:137], a[100:103], a[124:127], v[134:137]
    ds_read_b128 a[148:151], v77 offset:51200
    v_lshl_add_u32 v38, v5, 4, v38
    v_mfma_f32_16x16x32_bf16 v[118:121], a[100:103], a[120:123], v[118:121]
    ds_read_b128 a[144:147], v77 offset:49152
    buffer_load_dwordx4 v56, s[40:43], s71 offen offset:3072 lds
    v_mfma_f32_16x16x32_bf16 v[102:105], a[100:103], a[116:119], v[102:105]
    ds_read_b64_tr_b16 a[132:133], v79 offset:57344
    v_lshl_add_u32 v38, v13, 6, v38
    v_mfma_f32_16x16x32_bf16 v[86:89], a[100:103], a[112:115], v[86:89]
    ds_read_b64_tr_b16 a[134:135], v79 offset:58368
    s_waitcnt lgkmcnt(10)
    v_mfma_f32_16x16x32_bf16 v[90:93], a[104:107], a[112:115], v[90:93]
    ds_read_b64_tr_b16 a[136:137], v80 offset:57344
    v_add_u32 v38, s61, v38
    v_mfma_f32_16x16x32_bf16 v[106:109], a[104:107], a[116:119], v[106:109]
    ds_read_b64_tr_b16 a[138:139], v80 offset:58368
    s_add_u32 m0, s66, 65536
    s_lshl4_add_u32 s70, s69, s67
    buffer_load_dwordx4 v49, s[36:39], s70 offen offset:0 lds
    v_mfma_f32_16x16x32_bf16 v[122:125], a[104:107], a[120:123], v[122:125]
    ds_read_b64_tr_b16 a[140:141], v81 offset:57344
    s_lshr_b32 s13, s2, 5
    v_mfma_f32_16x16x32_bf16 v[138:141], a[104:107], a[124:127], v[138:141]
    ds_read_b64_tr_b16 a[142:143], v81 offset:58368
    s_lshl_b32 s13, s13, 9
    s_waitcnt lgkmcnt(12)
    v_mfma_f32_16x16x32_bf16 v[142:145], a[108:111], a[124:127], v[142:145]
    ds_read2st64_b32 v[202:203], v64 offset0:17 offset1:81
    s_add_u32 s13, s13, 65536
    v_mfma_f32_16x16x32_bf16 v[126:129], a[108:111], a[120:123], v[126:129]
    buffer_load_dwordx4 v50, s[36:39], s70 offen offset:1024 lds
    ds_read2st64_b32 v[204:205], v64 offset0:49 offset1:113
    v_mfma_f32_16x16x32_bf16 v[110:113], a[108:111], a[116:119], v[110:113]
    ds_read2st64_b32 v[206:207], v65 offset0:17 offset1:81
    v_and_b32 v24, 31, v1
    v_mfma_f32_16x16x32_bf16 v[94:97], a[108:111], a[112:115], v[94:97]
    ds_read2st64_b32 v[208:209], v65 offset0:49 offset1:113
    s_waitcnt lgkmcnt(10)
    v_mfma_f32_16x16x32_bf16 v[82:85], a[128:131], a[144:147], v[82:85]
    ds_read2st64_b32 v[210:211], v66 offset0:17 offset1:81
    v_lshlrev_b32 v24, 4, v24
    v_mfma_f32_16x16x32_bf16 v[98:101], a[128:131], a[148:151], v[98:101]
    buffer_load_dwordx4 v51, s[36:39], s70 offen offset:2048 lds
    ds_read2st64_b32 v[212:213], v66 offset0:49 offset1:113
    v_mfma_f32_16x16x32_bf16 v[114:117], a[128:131], a[152:155], v[114:117]
    s_lshl_b32 s60, s82, 12
    s_lshl_b32 s61, s59, 2
    v_mfma_f32_16x16x32_bf16 v[130:133], a[128:131], a[156:159], v[130:133]
    s_waitcnt vmcnt(11) lgkmcnt(6)
    s_barrier
    v_mfma_f32_16x16x32_bf16 v[134:137], a[132:135], a[156:159], v[134:137]
    ds_read_b64_tr_b16 a[96:97], v78 offset:0
    s_sub_u32 s60, s60, s61
    v_mfma_f32_16x16x32_bf16 v[118:121], a[132:135], a[152:155], v[118:121]
    ds_read_b64_tr_b16 a[98:99], v78 offset:1024
    buffer_load_dwordx4 v52, s[36:39], s70 offen offset:3072 lds
    v_mfma_f32_16x16x32_bf16 v[102:105], a[132:135], a[148:151], v[102:105]
    ds_read_b128 a[124:127], v76 offset:6144
    s_add_u32 s4, s60, 2097152
    v_mfma_f32_16x16x32_bf16 v[86:89], a[132:135], a[144:147], v[86:89]
    ds_read_b128 a[120:123], v76 offset:4096
    s_mul_i32 s71, s69, 28672
    s_add_u32 m0, s66, 131072
    s_add_u32 s71, s71, s68
    buffer_load_dwordx4 v53, s[40:43], s71 offen offset:0 lds
    v_mfma_f32_16x16x32_bf16 v[90:93], a[136:139], a[144:147], v[90:93]
    ds_read_b128 a[116:119], v76 offset:2048
    s_lshl_b32 s61, s59, 5
    v_mfma_f32_16x16x32_bf16 v[106:109], a[136:139], a[148:151], v[106:109]
    ds_read_b128 a[112:115], v76 offset:0
    buffer_load_dwordx4 v54, s[40:43], s71 offen offset:1024 lds
    s_add_u32 s69, s69, 8
    v_mfma_f32_16x16x32_bf16 v[122:125], a[136:139], a[152:155], v[122:125]
    ds_read_b64_tr_b16 a[100:101], v79 offset:0
    s_add_u32 s5, s78, s61
    v_mfma_f32_16x16x32_bf16 v[138:141], a[136:139], a[156:159], v[138:141]
    ds_read_b64_tr_b16 a[102:103], v79 offset:1024
    v_lshl_add_u32 v39, v1, 3, s5
    v_mfma_f32_16x16x32_bf16 v[142:145], a[140:143], a[156:159], v[142:145]
    ds_read_b64_tr_b16 a[104:105], v80 offset:0
    s_lshl2_add_u32 s60, s59, s5
    v_mfma_f32_16x16x32_bf16 v[126:129], a[140:143], a[152:155], v[126:129]
    ds_read_b64_tr_b16 a[106:107], v80 offset:1024
    buffer_load_dwordx4 v55, s[40:43], s71 offen offset:2048 lds
    s_and_b32 s69, s69, 63
    v_mfma_f32_16x16x32_bf16 v[110:113], a[140:143], a[148:151], v[110:113]
    ds_read_b64_tr_b16 a[108:109], v81 offset:0
    v_mov_b32 v40, s60
    v_mfma_f32_16x16x32_bf16 v[94:97], a[140:143], a[144:147], v[94:97]
    ds_read_b64_tr_b16 a[110:111], v81 offset:1024
    s_waitcnt lgkmcnt(6)
    v_mfma_f32_16x16x32_bf16 v[82:85], a[96:99], a[112:115], v[82:85]
    ds_read_b64_tr_b16 a[128:129], v78 offset:8192
    v_lshl_add_u32 v8, v4, 4, s78
    v_mfma_f32_16x16x32_bf16 v[98:101], a[96:99], a[116:119], v[98:101]
    ds_read_b64_tr_b16 a[130:131], v78 offset:9216
    buffer_load_dwordx4 v56, s[40:43], s71 offen offset:3072 lds
    v_mfma_f32_16x16x32_bf16 v[114:117], a[96:99], a[120:123], v[114:117]
    ds_read_b128 a[156:159], v77 offset:6144
    s_lshl_b32 s60, s76, 10
    v_mfma_f32_16x16x32_bf16 v[130:133], a[96:99], a[124:127], v[130:133]
    ds_read_b128 a[152:155], v77 offset:4096
    s_waitcnt lgkmcnt(8)
    v_mfma_f32_16x16x32_bf16 v[134:137], a[100:103], a[124:127], v[134:137]
    ds_read_b128 a[148:151], v77 offset:2048
    s_add_u32 s60, s60, 622592
    v_mfma_f32_16x16x32_bf16 v[118:121], a[100:103], a[120:123], v[118:121]
    ds_read_b128 a[144:147], v77 offset:0
    s_add_u32 m0, s66, 81920
    s_lshl4_add_u32 s70, s69, s67
    buffer_load_dwordx4 v49, s[36:39], s70 offen offset:0 lds
    v_mfma_f32_16x16x32_bf16 v[102:105], a[100:103], a[116:119], v[102:105]
    ds_read_b64_tr_b16 a[132:133], v79 offset:8192
    s_lshl_b32 s61, s75, 10
    v_mfma_f32_16x16x32_bf16 v[86:89], a[100:103], a[112:115], v[86:89]
    ds_read_b64_tr_b16 a[134:135], v79 offset:9216
    s_waitcnt lgkmcnt(10)
    v_mfma_f32_16x16x32_bf16 v[90:93], a[104:107], a[112:115], v[90:93]
    ds_read_b64_tr_b16 a[136:137], v80 offset:8192
    s_add_u32 s83, s61, 555008
    v_mfma_f32_16x16x32_bf16 v[106:109], a[104:107], a[116:119], v[106:109]
    ds_read_b64_tr_b16 a[138:139], v80 offset:9216
    buffer_load_dwordx4 v50, s[36:39], s70 offen offset:1024 lds
    v_mfma_f32_16x16x32_bf16 v[122:125], a[104:107], a[120:123], v[122:125]
    ds_read_b64_tr_b16 a[140:141], v81 offset:8192
    s_add_u32 s61, s61, 523264
    v_mfma_f32_16x16x32_bf16 v[138:141], a[104:107], a[124:127], v[138:141]
    ds_read_b64_tr_b16 a[142:143], v81 offset:9216
    v_add_f32 v178, v178, v180
    s_waitcnt lgkmcnt(12)
    v_mfma_f32_16x16x32_bf16 v[142:145], a[108:111], a[124:127], v[142:145]
    v_add_f32 v179, v179, v181
    v_add_f32 v182, v182, v184
    v_mfma_f32_16x16x32_bf16 v[126:129], a[108:111], a[120:123], v[126:129]
    buffer_load_dwordx4 v51, s[36:39], s70 offen offset:2048 lds
    v_add_f32 v183, v183, v185
    v_mfma_f32_16x16x32_bf16 v[110:113], a[108:111], a[116:119], v[110:113]
    v_add_f32 v186, v186, v188
    v_add_f32 v187, v187, v189
    v_mfma_f32_16x16x32_bf16 v[94:97], a[108:111], a[112:115], v[94:97]
    v_add_f32 v190, v190, v192
    s_waitcnt lgkmcnt(6)
    v_mfma_f32_16x16x32_bf16 v[82:85], a[128:131], a[144:147], v[82:85]
    v_add_f32 v191, v191, v193
    v_add_f32 v194, v194, v196
    v_mfma_f32_16x16x32_bf16 v[98:101], a[128:131], a[148:151], v[98:101]
    buffer_load_dwordx4 v52, s[36:39], s70 offen offset:3072 lds
    v_add_f32 v195, v195, v197
    v_mfma_f32_16x16x32_bf16 v[114:117], a[128:131], a[152:155], v[114:117]
    v_add_f32 v198, v198, v200
    v_add_f32 v199, v199, v201
    v_mfma_f32_16x16x32_bf16 v[130:133], a[128:131], a[156:159], v[130:133]
    s_waitcnt vmcnt(12) lgkmcnt(0)
    s_barrier
    v_mfma_f32_16x16x32_bf16 v[134:137], a[132:135], a[156:159], v[134:137]
    ds_read_b64_tr_b16 a[96:97], v78 offset:16384
    v_add_f32 v202, v202, v204
Lpg1:
    s_cbranch_execz Liw_ret
    v_mfma_f32_16x16x32_bf16 v[118:121], a[132:135], a[152:155], v[118:121]
    ds_read_b64_tr_b16 a[98:99], v78 offset:17408
    s_mul_i32 s71, s69, 28672
    s_add_u32 m0, s66, 147456
    s_add_u32 s71, s71, s68
    buffer_load_dwordx4 v53, s[40:43], s71 offen offset:0 lds
    v_mfma_f32_16x16x32_bf16 v[102:105], a[132:135], a[148:151], v[102:105]
    ds_read_b128 a[124:127], v76 offset:22528
    v_add_f32 v203, v203, v205
    v_mfma_f32_16x16x32_bf16 v[86:89], a[132:135], a[144:147], v[86:89]
    ds_read_b128 a[120:123], v76 offset:20480
    buffer_load_dwordx4 v54, s[40:43], s71 offen offset:1024 lds
    s_add_u32 s69, s69, 8
    v_mfma_f32_16x16x32_bf16 v[90:93], a[136:139], a[144:147], v[90:93]
    ds_read_b128 a[116:119], v76 offset:18432
    v_add_f32 v206, v206, v208
    v_mfma_f32_16x16x32_bf16 v[106:109], a[136:139], a[148:151], v[106:109]
    ds_read_b128 a[112:115], v76 offset:16384
    buffer_load_dwordx4 v55, s[40:43], s71 offen offset:2048 lds
    s_and_b32 s69, s69, 63
    v_mfma_f32_16x16x32_bf16 v[122:125], a[136:139], a[152:155], v[122:125]
    ds_read_b64_tr_b16 a[100:101], v79 offset:16384
    v_add_f32 v207, v207, v209
    v_mfma_f32_16x16x32_bf16 v[138:141], a[136:139], a[156:159], v[138:141]
    ds_read_b64_tr_b16 a[102:103], v79 offset:17408
    v_add_f32 v210, v210, v212
    v_mfma_f32_16x16x32_bf16 v[142:145], a[140:143], a[156:159], v[142:145]
    ds_read_b64_tr_b16 a[104:105], v80 offset:16384
    v_add_f32 v211, v211, v213
    v_mfma_f32_16x16x32_bf16 v[126:129], a[140:143], a[152:155], v[126:129]
    ds_read_b64_tr_b16 a[106:107], v80 offset:17408
    buffer_load_dwordx4 v56, s[40:43], s71 offen offset:3072 lds
    v_mfma_f32_16x16x32_bf16 v[110:113], a[140:143], a[148:151], v[110:113]
    ds_read_b64_tr_b16 a[108:109], v81 offset:16384
    v_cvt_pk_bf16_f32 v218, v178, v182
    v_mfma_f32_16x16x32_bf16 v[94:97], a[140:143], a[144:147], v[94:97]
    ds_read_b64_tr_b16 a[110:111], v81 offset:17408
    s_waitcnt lgkmcnt(6)
    v_mfma_f32_16x16x32_bf16 v[82:85], a[96:99], a[112:115], v[82:85]
    ds_read_b64_tr_b16 a[128:129], v78 offset:24576
    v_cvt_pk_bf16_f32 v219, v186, v190
    v_mfma_f32_16x16x32_bf16 v[98:101], a[96:99], a[116:119], v[98:101]
    ds_read_b64_tr_b16 a[130:131], v78 offset:25600
    s_add_u32 m0, s66, 98304
    s_add_u32 s77, s77, 32768
    buffer_load_dwordx4 v25, s[44:47], s77 offen offset:0 lds
    v_mfma_f32_16x16x32_bf16 v[114:117], a[96:99], a[120:123], v[114:117]
    ds_read_b128 a[156:159], v77 offset:22528
    v_cvt_pk_bf16_f32 v220, v194, v198
    v_mfma_f32_16x16x32_bf16 v[130:133], a[96:99], a[124:127], v[130:133]
    ds_read_b128 a[152:155], v77 offset:20480
    s_waitcnt lgkmcnt(8)
    v_mfma_f32_16x16x32_bf16 v[134:137], a[100:103], a[124:127], v[134:137]
    ds_read_b128 a[148:151], v77 offset:18432
    v_cvt_pk_bf16_f32 v221, v202, v206
    v_mfma_f32_16x16x32_bf16 v[118:121], a[100:103], a[120:123], v[118:121]
    ds_read_b128 a[144:147], v77 offset:16384
    buffer_load_dwordx4 v26, s[44:47], s77 offen offset:1024 lds
    v_mfma_f32_16x16x32_bf16 v[102:105], a[100:103], a[116:119], v[102:105]
    ds_read_b64_tr_b16 a[132:133], v79 offset:24576
    v_cvt_pk_bf16_f32 v214, v182, v186
    v_mfma_f32_16x16x32_bf16 v[86:89], a[100:103], a[112:115], v[86:89]
    ds_read_b64_tr_b16 a[134:135], v79 offset:25600
    s_waitcnt lgkmcnt(10)
    v_mfma_f32_16x16x32_bf16 v[90:93], a[104:107], a[112:115], v[90:93]
    ds_read_b64_tr_b16 a[136:137], v80 offset:24576
    v_cvt_pk_bf16_f32 v215, v190, v194
    v_mfma_f32_16x16x32_bf16 v[106:109], a[104:107], a[116:119], v[106:109]
    ds_read_b64_tr_b16 a[138:139], v80 offset:25600
    buffer_load_dwordx4 v27, s[44:47], s77 offen offset:2048 lds
    v_mfma_f32_16x16x32_bf16 v[122:125], a[104:107], a[120:123], v[122:125]
    ds_read_b64_tr_b16 a[140:141], v81 offset:24576
    v_cvt_pk_bf16_f32 v216, v198, v202
    v_mfma_f32_16x16x32_bf16 v[138:141], a[104:107], a[124:127], v[138:141]
    ds_read_b64_tr_b16 a[142:143], v81 offset:25600
    v_cvt_pk_bf16_f32 v217, v206, v210
    s_waitcnt lgkmcnt(12)
    v_mfma_f32_16x16x32_bf16 v[142:145], a[108:111], a[124:127], v[142:145]
    v_cvt_pk_bf16_f32 v226, v179, v183
    v_cvt_pk_bf16_f32 v227, v187, v191
    v_mfma_f32_16x16x32_bf16 v[126:129], a[108:111], a[120:123], v[126:129]
    buffer_load_dwordx4 v28, s[44:47], s77 offen offset:3072 lds
    v_cvt_pk_bf16_f32 v228, v195, v199
    v_mfma_f32_16x16x32_bf16 v[110:113], a[108:111], a[116:119], v[110:113]
    v_cvt_pk_bf16_f32 v229, v203, v207
    v_cvt_pk_bf16_f32 v222, v183, v187
    v_mfma_f32_16x16x32_bf16 v[94:97], a[108:111], a[112:115], v[94:97]
    v_cvt_pk_bf16_f32 v223, v191, v195
    s_waitcnt lgkmcnt(6)
    v_mfma_f32_16x16x32_bf16 v[82:85], a[128:131], a[144:147], v[82:85]
    v_cvt_pk_bf16_f32 v224, v199, v203
    v_cvt_pk_bf16_f32 v225, v207, v211
    s_add_u32 m0, s78, 4352
    v_mfma_f32_16x16x32_bf16 v[98:101], a[128:131], a[148:151], v[98:101]
    buffer_load_dwordx4 v20, s[48:51], s60 offen offset:0 sc1 lds
    v_mfma_f32_16x16x32_bf16 v[114:117], a[128:131], a[152:155], v[114:117]
    v_mfma_f32_16x16x32_bf16 v[130:133], a[128:131], a[156:159], v[130:133]
    s_waitcnt vmcnt(13) lgkmcnt(0)
    s_barrier
    v_mfma_f32_16x16x32_bf16 v[134:137], a[132:135], a[156:159], v[134:137]
    ds_read_b64_tr_b16 a[96:97], v78 offset:32768
    v_mfma_f32_16x16x32_bf16 v[118:121], a[132:135], a[152:155], v[118:121]
    ds_read_b64_tr_b16 a[98:99], v78 offset:33792
    buffer_load_dwordx4 v20, s[48:51], s61 offen offset:1024 sc1 lds
    v_mfma_f32_16x16x32_bf16 v[102:105], a[132:135], a[148:151], v[102:105]
    ds_read_b128 a[124:127], v76 offset:38912
    v_mfma_f32_16x16x32_bf16 v[86:89], a[132:135], a[144:147], v[86:89]
    ds_read_b128 a[120:123], v76 offset:36864
    v_mfma_f32_16x16x32_bf16 v[90:93], a[136:139], a[144:147], v[90:93]
    ds_read_b128 a[116:119], v76 offset:34816
    v_mfma_f32_16x16x32_bf16 v[106:109], a[136:139], a[148:151], v[106:109]
    ds_read_b128 a[112:115], v76 offset:32768
    buffer_load_dwordx4 v20, s[48:51], s83 offen offset:2048 sc1 lds
    v_mfma_f32_16x16x32_bf16 v[122:125], a[136:139], a[152:155], v[122:125]
    ds_read_b64_tr_b16 a[100:101], v79 offset:32768
    v_mfma_f32_16x16x32_bf16 v[138:141], a[136:139], a[156:159], v[138:141]
    ds_read_b64_tr_b16 a[102:103], v79 offset:33792
    v_mfma_f32_16x16x32_bf16 v[142:145], a[140:143], a[156:159], v[142:145]
    ds_read_b64_tr_b16 a[104:105], v80 offset:32768
    v_mfma_f32_16x16x32_bf16 v[126:129], a[140:143], a[152:155], v[126:129]
    ds_read_b64_tr_b16 a[106:107], v80 offset:33792
    s_add_u32 m0, s78, 32768
    s_add_u32 s77, s77, 32768
    buffer_load_dwordx4 v25, s[44:47], s77 offen offset:0 lds
    v_mfma_f32_16x16x32_bf16 v[110:113], a[140:143], a[148:151], v[110:113]
    ds_read_b64_tr_b16 a[108:109], v81 offset:32768
    v_mfma_f32_16x16x32_bf16 v[94:97], a[140:143], a[144:147], v[94:97]
    ds_read_b64_tr_b16 a[110:111], v81 offset:33792
    s_waitcnt lgkmcnt(6)
    v_mfma_f32_16x16x32_bf16 v[82:85], a[96:99], a[112:115], v[82:85]
    ds_read_b64_tr_b16 a[128:129], v78 offset:40960
    v_mfma_f32_16x16x32_bf16 v[98:101], a[96:99], a[116:119], v[98:101]
    ds_read_b64_tr_b16 a[130:131], v78 offset:41984
    buffer_load_dwordx4 v26, s[44:47], s77 offen offset:1024 lds
    v_mfma_f32_16x16x32_bf16 v[114:117], a[96:99], a[120:123], v[114:117]
    ds_read_b128 a[156:159], v77 offset:38912
    v_mfma_f32_16x16x32_bf16 v[130:133], a[96:99], a[124:127], v[130:133]
    ds_read_b128 a[152:155], v77 offset:36864
    s_waitcnt lgkmcnt(8)
    v_mfma_f32_16x16x32_bf16 v[134:137], a[100:103], a[124:127], v[134:137]
    ds_read_b128 a[148:151], v77 offset:34816
    v_mfma_f32_16x16x32_bf16 v[118:121], a[100:103], a[120:123], v[118:121]
    ds_read_b128 a[144:147], v77 offset:32768
    buffer_load_dwordx4 v27, s[44:47], s77 offen offset:2048 lds
    v_mfma_f32_16x16x32_bf16 v[102:105], a[100:103], a[116:119], v[102:105]
    ds_read_b64_tr_b16 a[132:133], v79 offset:40960
    v_mfma_f32_16x16x32_bf16 v[86:89], a[100:103], a[112:115], v[86:89]
    ds_read_b64_tr_b16 a[134:135], v79 offset:41984
    s_waitcnt lgkmcnt(10)
    v_mfma_f32_16x16x32_bf16 v[90:93], a[104:107], a[112:115], v[90:93]
    ds_read_b64_tr_b16 a[136:137], v80 offset:40960
    s_mul_i32 s72, s75, 224
    v_mfma_f32_16x16x32_bf16 v[106:109], a[104:107], a[116:119], v[106:109]
    ds_read_b64_tr_b16 a[138:139], v80 offset:41984
    buffer_load_dwordx4 v28, s[44:47], s77 offen offset:3072 lds
    v_mfma_f32_16x16x32_bf16 v[122:125], a[104:107], a[120:123], v[122:125]
    ds_read_b64_tr_b16 a[140:141], v81 offset:40960
    s_lshl1_add_u32 s72, s76, s72
    v_mfma_f32_16x16x32_bf16 v[138:141], a[104:107], a[124:127], v[138:141]
    ds_read_b64_tr_b16 a[142:143], v81 offset:41984
    s_lshl_b32 s72, s72, 10
    s_waitcnt lgkmcnt(12)
    v_mfma_f32_16x16x32_bf16 v[142:145], a[108:111], a[124:127], v[142:145]
    s_waitcnt vmcnt(7)
    ds_read_b64_tr_b16 a[0:1], v29 offset:32768
    ds_read_b64_tr_b16 a[2:3], v29 offset:34816
    v_mfma_f32_16x16x32_bf16 v[126:129], a[108:111], a[120:123], v[126:129]
    s_add_u32 m0, s78, 36864
    s_add_u32 s77, s77, 32768
    buffer_load_dwordx4 v25, s[44:47], s77 offen offset:0 lds
    ds_read_b64_tr_b16 a[4:5], v30 offset:32768
    v_mfma_f32_16x16x32_bf16 v[110:113], a[108:111], a[116:119], v[110:113]
    ds_read_b64_tr_b16 a[6:7], v30 offset:34816
    ds_read_b64_tr_b16 a[8:9], v31 offset:32768
    v_mfma_f32_16x16x32_bf16 v[94:97], a[108:111], a[112:115], v[94:97]
    ds_read_b64_tr_b16 a[10:11], v31 offset:34816
    ds_read_b64_tr_b16 a[12:13], v32 offset:32768
    s_waitcnt lgkmcnt(13)
    v_mfma_f32_16x16x32_bf16 v[82:85], a[128:131], a[144:147], v[82:85]
    ds_read_b64_tr_b16 a[14:15], v32 offset:34816
    s_add_u32 s72, s72, 8388608
    v_mfma_f32_16x16x32_bf16 v[98:101], a[128:131], a[148:151], v[98:101]
    buffer_load_dwordx4 v26, s[44:47], s77 offen offset:1024 lds
    s_add_u32 s73, s72, 57344
    v_mfma_f32_16x16x32_bf16 v[114:117], a[128:131], a[152:155], v[114:117]
    s_add_u32 s67, s72, 114688
    s_add_u32 s68, s72, 172032
    v_mfma_f32_16x16x32_bf16 v[130:133], a[128:131], a[156:159], v[130:133]
    s_waitcnt lgkmcnt(8)
    s_barrier
    v_mfma_f32_16x16x32_bf16 v[134:137], a[132:135], a[156:159], v[134:137]
    ds_read_b64_tr_b16 a[96:97], v78 offset:49152
    s_mul_i32 s62, s76, 9363
    v_mfma_f32_16x16x32_bf16 v[118:121], a[132:135], a[152:155], v[118:121]
    ds_read_b64_tr_b16 a[98:99], v78 offset:50176
    buffer_load_dwordx4 v27, s[44:47], s77 offen offset:2048 lds
    v_mfma_f32_16x16x32_bf16 v[102:105], a[132:135], a[148:151], v[102:105]
    ds_read_b128 a[124:127], v76 offset:55296
    s_lshr_b32 s62, s62, 16
    v_mfma_f32_16x16x32_bf16 v[86:89], a[132:135], a[144:147], v[86:89]
    ds_read_b128 a[120:123], v76 offset:53248
    s_mul_i32 s63, s62, 7
    v_mfma_f32_16x16x32_bf16 v[90:93], a[136:139], a[144:147], v[90:93]
    ds_read_b128 a[116:119], v76 offset:51200
    s_sub_u32 s63, s76, s63
    v_mfma_f32_16x16x32_bf16 v[106:109], a[136:139], a[148:151], v[106:109]
    ds_read_b128 a[112:115], v76 offset:49152
    buffer_load_dwordx4 v28, s[44:47], s77 offen offset:3072 lds
    v_mfma_f32_16x16x32_bf16 v[122:125], a[136:139], a[152:155], v[122:125]
    ds_read_b64_tr_b16 a[100:101], v79 offset:49152
    s_lshl2_add_u32 s74, s75, s62
    v_mfma_f32_16x16x32_bf16 v[138:141], a[136:139], a[156:159], v[138:141]
    ds_read_b64_tr_b16 a[102:103], v79 offset:50176
    s_lshl_b32 s74, s74, 7
    v_mfma_f32_16x16x32_bf16 v[142:145], a[140:143], a[156:159], v[142:145]
    ds_read_b64_tr_b16 a[104:105], v80 offset:49152
    s_lshl_b32 s63, s63, 2
    v_mfma_f32_16x16x32_bf16 v[126:129], a[140:143], a[152:155], v[126:129]
    ds_read_b64_tr_b16 a[106:107], v80 offset:50176
    buffer_load_dword v7, v24, s[48:51], s13 offen sc1
    v_mfma_f32_16x16x32_bf16 v[110:113], a[140:143], a[148:151], v[110:113]
    ds_read_b64_tr_b16 a[108:109], v81 offset:49152
    s_add_u32 s74, s63, s74
    v_mfma_f32_16x16x32_bf16 v[94:97], a[140:143], a[144:147], v[94:97]
    ds_read_b64_tr_b16 a[110:111], v81 offset:50176
    s_waitcnt lgkmcnt(6)
    v_mfma_f32_16x16x32_bf16 v[82:85], a[96:99], a[112:115], v[82:85]
    ds_read_b64_tr_b16 a[128:129], v78 offset:57344
    s_add_u32 s74, s74, 131072
    v_mfma_f32_16x16x32_bf16 v[98:101], a[96:99], a[116:119], v[98:101]
    ds_read_b64_tr_b16 a[130:131], v78 offset:58368
    s_add_u32 m0, s66, 114688
    s_add_u32 s77, s77, 32768
    buffer_load_dwordx4 v25, s[44:47], s77 offen offset:0 lds
    v_mfma_f32_16x16x32_bf16 v[114:117], a[96:99], a[120:123], v[114:117]
    ds_read_b128 a[156:159], v77 offset:55296
    v_mfma_f32_16x16x32_bf16 v[130:133], a[96:99], a[124:127], v[130:133]
    ds_read_b128 a[152:155], v77 offset:53248
    s_waitcnt lgkmcnt(8)
    v_mfma_f32_16x16x32_bf16 v[134:137], a[100:103], a[124:127], v[134:137]
    ds_read_b128 a[148:151], v77 offset:51200
    v_mfma_f32_16x16x32_bf16 v[118:121], a[100:103], a[120:123], v[118:121]
    ds_read_b128 a[144:147], v77 offset:49152
    buffer_load_dwordx4 v26, s[44:47], s77 offen offset:1024 lds
    v_mfma_f32_16x16x32_bf16 v[102:105], a[100:103], a[116:119], v[102:105]
    ds_read_b64_tr_b16 a[132:133], v79 offset:57344
    v_mfma_f32_16x16x32_bf16 v[86:89], a[100:103], a[112:115], v[86:89]
    ds_read_b64_tr_b16 a[134:135], v79 offset:58368
    s_waitcnt lgkmcnt(10)
    v_mfma_f32_16x16x32_bf16 v[90:93], a[104:107], a[112:115], v[90:93]
    ds_read_b64_tr_b16 a[136:137], v80 offset:57344
    v_mfma_f32_16x16x32_bf16 v[106:109], a[104:107], a[116:119], v[106:109]
    ds_read_b64_tr_b16 a[138:139], v80 offset:58368
    buffer_load_dwordx4 v27, s[44:47], s77 offen offset:2048 lds
    v_mfma_f32_16x16x32_bf16 v[122:125], a[104:107], a[120:123], v[122:125]
    ds_read_b64_tr_b16 a[140:141], v81 offset:57344
    v_mfma_f32_16x16x32_bf16 v[138:141], a[104:107], a[124:127], v[138:141]
    ds_read_b64_tr_b16 a[142:143], v81 offset:58368
    s_waitcnt lgkmcnt(12)
    v_mfma_f32_16x16x32_bf16 v[142:145], a[108:111], a[124:127], v[142:145]
    s_waitcnt vmcnt(12)
    ds_read_b128 v[146:149], v8 offset:4352
    ds_read_b128 v[150:153], v8 offset:4608
    v_mfma_f32_16x16x32_bf16 v[126:129], a[108:111], a[120:123], v[126:129]
    buffer_load_dwordx4 v28, s[44:47], s77 offen offset:3072 lds
    ds_read_b128 v[154:157], v8 offset:4864
    ds_read_b128 v[158:161], v8 offset:5120
    v_mfma_f32_16x16x32_bf16 v[110:113], a[108:111], a[116:119], v[110:113]
    ds_read_b128 v[162:165], v8 offset:5376
    ds_read_b128 v[166:169], v8 offset:5632
    v_mfma_f32_16x16x32_bf16 v[94:97], a[108:111], a[112:115], v[94:97]
    ds_read_b128 v[170:173], v8 offset:5888
    ds_read_b128 v[174:177], v8 offset:6144
    s_waitcnt lgkmcnt(14)
    v_mfma_f32_16x16x32_bf16 v[82:85], a[128:131], a[144:147], v[82:85]
    ds_read_b128 v[230:233], v8 offset:6400
    ds_read_b128 v[234:237], v8 offset:6656
    v_mfma_f32_16x16x32_bf16 v[98:101], a[128:131], a[148:151], v[98:101]
    s_add_u32 m0, s66, 65536
    s_add_u32 s77, s77, 32768
    buffer_load_dwordx4 v25, s[44:47], s77 offen offset:0 lds
    ds_read_b128 v[238:241], v8 offset:6912
    v_mfma_f32_16x16x32_bf16 v[114:117], a[128:131], a[152:155], v[114:117]
    ds_read_b128 v[242:245], v8 offset:7168
    v_mfma_f32_16x16x32_bf16 v[130:133], a[128:131], a[156:159], v[130:133]
    s_waitcnt lgkmcnt(12)
    s_barrier
    s_waitcnt lgkmcnt(11)
    v_xor_b32 v149, s64, v149
    v_mfma_f32_16x16x32_bf16 v[134:137], a[132:135], a[156:159], v[134:137]
    s_waitcnt lgkmcnt(10)
    v_xor_b32 v153, s64, v153
    s_waitcnt lgkmcnt(9)
    v_xor_b32 v157, s64, v157
    s_waitcnt lgkmcnt(8)
    v_xor_b32 v161, s64, v161
    v_mfma_f32_16x16x32_bf16 v[118:121], a[132:135], a[152:155], v[118:121]
    buffer_load_dwordx4 v26, s[44:47], s77 offen offset:1024 lds
    s_waitcnt lgkmcnt(7)
    v_xor_b32 v165, s64, v165
    s_waitcnt lgkmcnt(6)
    v_xor_b32 v169, s64, v169
    v_mfma_f32_16x16x32_bf16 v[102:105], a[132:135], a[148:151], v[102:105]
    s_waitcnt lgkmcnt(5)
    v_xor_b32 v173, s64, v173
    s_waitcnt lgkmcnt(4)
    v_xor_b32 v177, s64, v177
    s_waitcnt lgkmcnt(3)
    v_xor_b32 v233, s64, v233
    v_mfma_f32_16x16x32_bf16 v[86:89], a[132:135], a[144:147], v[86:89]
    s_waitcnt lgkmcnt(2)
    v_xor_b32 v237, s64, v237
    s_waitcnt lgkmcnt(1)
    v_xor_b32 v241, s64, v241
    s_waitcnt lgkmcnt(0)
    v_xor_b32 v245, s64, v245
    v_mfma_f32_16x16x32_bf16 v[90:93], a[136:139], a[144:147], v[90:93]
    s_waitcnt vmcnt(11)
    ds_read_b64_tr_b16 a[16:17], v33 offset:0
    v_or3_b32 v9, v149, v153, v157
    v_mfma_f32_16x16x32_bf16 v[106:109], a[136:139], a[148:151], v[106:109]
    buffer_load_dwordx4 v27, s[44:47], s77 offen offset:2048 lds
    ds_read_b64_tr_b16 a[18:19], v33 offset:2048
    v_or3_b32 v9, v9, v161, v165
    v_mfma_f32_16x16x32_bf16 v[122:125], a[136:139], a[152:155], v[122:125]
    ds_read_b64_tr_b16 a[20:21], v34 offset:0
    v_or3_b32 v9, v9, v169, v173
    v_or3_b32 v9, v9, v177, v233
    v_mfma_f32_16x16x32_bf16 v[138:141], a[136:139], a[156:159], v[138:141]
    ds_read_b64_tr_b16 a[22:23], v34 offset:2048
    v_or3_b32 v9, v9, v237, v241
    v_or3_b32 v9, v9, v245, v245
    v_mfma_f32_16x16x32_bf16 v[142:145], a[140:143], a[156:159], v[142:145]
    ds_read_b64_tr_b16 a[24:25], v35 offset:0
    v_cmp_ne_u32 vcc, 0, v9
    s_cbranch_vccnz Lretry0
Lback0:
    v_mfma_f32_16x16x32_bf16 v[126:129], a[140:143], a[152:155], v[126:129]
    buffer_load_dwordx4 v28, s[44:47], s77 offen offset:3072 lds
    ds_read_b64_tr_b16 a[26:27], v35 offset:2048
    v_mfma_f32_16x16x32_bf16 v[110:113], a[140:143], a[148:151], v[110:113]
    ds_read_b64_tr_b16 a[28:29], v36 offset:0
    v_mfma_f32_16x16x32_bf16 v[94:97], a[140:143], a[144:147], v[94:97]
    ds_read_b64_tr_b16 a[30:31], v36 offset:2048
    v_mfma_f32_16x16x32_bf16 v[82:85], v[146:149], v[162:165], v[82:85]
    s_waitcnt vmcnt(9)
    ds_read_b64_tr_b16 a[32:33], v33 offset:4096
    v_mfma_f32_16x16x32_bf16 v[86:89], v[150:153], v[162:165], v[86:89]
    s_add_u32 m0, s66, 131072
    s_add_u32 s77, s77, 32768
    buffer_load_dwordx4 v25, s[44:47], s77 offen offset:0 lds
    v_mfma_f32_16x16x32_bf16 v[90:93], v[154:157], v[162:165], v[90:93]
    ds_read_b64_tr_b16 a[34:35], v33 offset:6144
    v_mfma_f32_16x16x32_bf16 v[94:97], v[158:161], v[162:165], v[94:97]
    ds_read_b64_tr_b16 a[36:37], v34 offset:4096
    v_mfma_f32_16x16x32_bf16 v[98:101], v[146:149], v[166:169], v[98:101]
    ds_read_b64_tr_b16 a[38:39], v34 offset:6144
    v_mfma_f32_16x16x32_bf16 v[102:105], v[150:153], v[166:169], v[102:105]
    buffer_load_dwordx4 v26, s[44:47], s77 offen offset:1024 lds
    ds_read_b64_tr_b16 a[40:41], v35 offset:4096
    v_mfma_f32_16x16x32_bf16 v[106:109], v[154:157], v[166:169], v[106:109]
    ds_read_b64_tr_b16 a[42:43], v35 offset:6144
    v_mfma_f32_16x16x32_bf16 v[110:113], v[158:161], v[166:169], v[110:113]
    ds_read_b64_tr_b16 a[44:45], v36 offset:4096
    v_mfma_f32_16x16x32_bf16 v[114:117], v[146:149], v[170:173], v[114:117]
    ds_read_b64_tr_b16 a[46:47], v36 offset:6144
    v_mfma_f32_16x16x32_bf16 v[118:121], v[150:153], v[170:173], v[118:121]
    buffer_load_dwordx4 v27, s[44:47], s77 offen offset:2048 lds
    v_mfma_f32_16x16x32_bf16 v[122:125], v[154:157], v[170:173], v[122:125]
    v_mfma_f32_16x16x32_bf16 v[126:129], v[158:161], v[170:173], v[126:129]
    v_mfma_f32_16x16x32_bf16 v[130:133], v[146:149], v[174:177], v[130:133]
    v_add_u32 v33, 65536, v29
    v_add_u32 v34, 65536, v30
    v_add_u32 v35, 65536, v31
    v_add_u32 v36, 65536, v32
    v_mfma_f32_16x16x32_bf16 v[134:137], v[150:153], v[174:177], v[134:137]
    buffer_load_dwordx4 v28, s[44:47], s77 offen offset:3072 lds
    v_mfma_f32_16x16x32_bf16 v[138:141], v[154:157], v[174:177], v[138:141]
    v_mfma_f32_16x16x32_bf16 v[142:145], v[158:161], v[174:177], v[142:145]
    v_pk_mul_f32 v[246:247], v[82:83], v[82:83]
    v_pk_mul_f32 v[248:249], v[84:85], v[84:85]
    v_pk_mul_f32 v[250:251], v[86:87], v[86:87]
    v_pk_mul_f32 v[252:253], v[88:89], v[88:89]
    s_waitcnt vmcnt(12)
    v_cmp_ne_u32 vcc, s64, v7
    s_cbranch_vccnz Lretry3
Lback3:
    s_waitcnt lgkmcnt(0)
    s_add_u32 m0, s5, 33280
    s_nop 0
    buffer_load_dwordx4 v20, s[48:51], s4 offen offset:0 sc1 lds
    v_pk_fma_f32 v[246:247], v[246:247], v[230:231], v[230:231] op_sel:[0,1,0] op_sel_hi:[1,1,0]
    v_pk_fma_f32 v[248:249], v[248:249], v[230:231], v[230:231] op_sel:[0,1,0] op_sel_hi:[1,1,0]
    v_pk_fma_f32 v[250:251], v[250:251], v[230:231], v[230:231] op_sel:[0,1,0] op_sel_hi:[1,1,0]
    v_pk_fma_f32 v[252:253], v[252:253], v[230:231], v[230:231] op_sel:[0,1,0] op_sel_hi:[1,1,0]
    v_pk_mul_f32 v[246:247], v[246:247], v[82:83]
    v_pk_mul_f32 v[248:249], v[248:249], v[84:85]
    v_pk_mul_f32 v[250:251], v[250:251], v[86:87]
    v_pk_mul_f32 v[252:253], v[252:253], v[88:89]
    v_exp_f32 v246, v246
    v_exp_f32 v247, v247
    v_exp_f32 v248, v248
    v_exp_f32 v249, v249
    v_exp_f32 v250, v250
    buffer_load_dwordx4 v20, s[48:51], s4 offen offset:1024 sc1 lds
    v_exp_f32 v251, v251
    v_exp_f32 v252, v252
    v_exp_f32 v253, v253
    v_pk_fma_f32 v[246:247], v[246:247], v[232:233], v[232:233] op_sel_hi:[1,0,0]
    v_pk_fma_f32 v[248:249], v[248:249], v[232:233], v[232:233] op_sel_hi:[1,0,0]
    v_pk_fma_f32 v[250:251], v[250:251], v[232:233], v[232:233] op_sel_hi:[1,0,0]
    v_pk_fma_f32 v[252:253], v[252:253], v[232:233], v[232:233] op_sel_hi:[1,0,0]
    v_rcp_f32 v246, v246
    v_rcp_f32 v247, v247
    v_rcp_f32 v248, v248
    v_rcp_f32 v249, v249
    v_rcp_f32 v250, v250
    v_rcp_f32 v251, v251
    buffer_load_dwordx4 v20, s[48:51], s4 offen offset:2048 sc1 lds
    v_rcp_f32 v252, v252
    v_rcp_f32 v253, v253
    v_pk_mul_f32 v[246:247], v[246:247], v[82:83]
    v_pk_mul_f32 v[248:249], v[248:249], v[84:85]
    v_pk_mul_f32 v[250:251], v[250:251], v[86:87]
    v_pk_mul_f32 v[252:253], v[252:253], v[88:89]
    v_cvt_pk_bf16_f32 v82, v246, v247
    v_cvt_pk_bf16_f32 v83, v248, v249
    v_cvt_pk_bf16_f32 v84, v250, v251
    v_cvt_pk_bf16_f32 v85, v252, v253
    buffer_store_dwordx4 v[82:85], v20, s[48:51], s72 offen offset:0 sc1
    v_pk_mul_f32 v[246:247], v[90:91], v[90:91]
    v_pk_mul_f32 v[248:249], v[92:93], v[92:93]
    buffer_load_dwordx4 v20, s[48:51], s4 offen offset:3072 sc1 lds
    v_pk_mul_f32 v[250:251], v[94:95], v[94:95]
    v_pk_mul_f32 v[252:253], v[96:97], v[96:97]
    v_pk_fma_f32 v[246:247], v[246:247], v[230:231], v[230:231] op_sel:[0,1,0] op_sel_hi:[1,1,0]
    v_pk_fma_f32 v[248:249], v[248:249], v[230:231], v[230:231] op_sel:[0,1,0] op_sel_hi:[1,1,0]
    v_pk_fma_f32 v[250:251], v[250:251], v[230:231], v[230:231] op_sel:[0,1,0] op_sel_hi:[1,1,0]
    v_pk_fma_f32 v[252:253], v[252:253], v[230:231], v[230:231] op_sel:[0,1,0] op_sel_hi:[1,1,0]
    v_pk_mul_f32 v[246:247], v[246:247], v[90:91]
    v_pk_mul_f32 v[248:249], v[248:249], v[92:93]
    v_pk_mul_f32 v[250:251], v[250:251], v[94:95]
    v_pk_mul_f32 v[252:253], v[252:253], v[96:97]
    v_exp_f32 v246, v246
    v_exp_f32 v247, v247
    v_exp_f32 v248, v248
    s_add_u32 m0, s66, 81920
    s_add_u32 s77, s77, 32768
    buffer_load_dwordx4 v25, s[44:47], s77 offen offset:0 lds
    v_exp_f32 v249, v249
    v_exp_f32 v250, v250
    v_exp_f32 v251, v251
    v_exp_f32 v252, v252
    v_exp_f32 v253, v253
    v_pk_fma_f32 v[246:247], v[246:247], v[232:233], v[232:233] op_sel_hi:[1,0,0]
    v_pk_fma_f32 v[248:249], v[248:249], v[232:233], v[232:233] op_sel_hi:[1,0,0]
    v_pk_fma_f32 v[250:251], v[250:251], v[232:233], v[232:233] op_sel_hi:[1,0,0]
    v_pk_fma_f32 v[252:253], v[252:253], v[232:233], v[232:233] op_sel_hi:[1,0,0]
    v_rcp_f32 v246, v246
    v_rcp_f32 v247, v247
    v_rcp_f32 v248, v248
    v_rcp_f32 v249, v249
    buffer_load_dwordx4 v26, s[44:47], s77 offen offset:1024 lds
    v_rcp_f32 v250, v250
    v_rcp_f32 v251, v251
    v_rcp_f32 v252, v252
    v_rcp_f32 v253, v253
    v_pk_mul_f32 v[246:247], v[246:247], v[90:91]
    v_pk_mul_f32 v[248:249], v[248:249], v[92:93]
    v_pk_mul_f32 v[250:251], v[250:251], v[94:95]
    v_pk_mul_f32 v[252:253], v[252:253], v[96:97]
    v_cvt_pk_bf16_f32 v90, v246, v247
    v_cvt_pk_bf16_f32 v91, v248, v249
    v_cvt_pk_bf16_f32 v92, v250, v251
    v_cvt_pk_bf16_f32 v93, v252, v253
    buffer_store_dwordx4 v[90:93], v20, s[48:51], s72 offen offset:1024 sc1
    buffer_load_dwordx4 v27, s[44:47], s77 offen offset:2048 lds
    v_pk_mul_f32 v[246:247], v[98:99], v[98:99]
    v_pk_mul_f32 v[248:249], v[100:101], v[100:101]
    v_pk_mul_f32 v[250:251], v[102:103], v[102:103]
    v_pk_mul_f32 v[252:253], v[104:105], v[104:105]
    v_pk_fma_f32 v[246:247], v[246:247], v[234:235], v[234:235] op_sel:[0,1,0] op_sel_hi:[1,1,0]
    v_pk_fma_f32 v[248:249], v[248:249], v[234:235], v[234:235] op_sel:[0,1,0] op_sel_hi:[1,1,0]
    v_pk_fma_f32 v[250:251], v[250:251], v[234:235], v[234:235] op_sel:[0,1,0] op_sel_hi:[1,1,0]
    v_pk_fma_f32 v[252:253], v[252:253], v[234:235], v[234:235] op_sel:[0,1,0] op_sel_hi:[1,1,0]
    v_pk_mul_f32 v[246:247], v[246:247], v[98:99]
    v_pk_mul_f32 v[248:249], v[248:249], v[100:101]
    v_pk_mul_f32 v[250:251], v[250:251], v[102:103]
    v_pk_mul_f32 v[252:253], v[252:253], v[104:105]
    v_exp_f32 v246, v246
    buffer_load_dwordx4 v28, s[44:47], s77 offen offset:3072 lds
    v_exp_f32 v247, v247
    v_exp_f32 v248, v248
    v_exp_f32 v249, v249
    v_exp_f32 v250, v250
    v_exp_f32 v251, v251
    v_exp_f32 v252, v252
    v_exp_f32 v253, v253
    v_pk_fma_f32 v[246:247], v[246:247], v[236:237], v[236:237] op_sel_hi:[1,0,0]
    v_pk_fma_f32 v[248:249], v[248:249], v[236:237], v[236:237] op_sel_hi:[1,0,0]
    v_pk_fma_f32 v[250:251], v[250:251], v[236:237], v[236:237] op_sel_hi:[1,0,0]
    v_pk_fma_f32 v[252:253], v[252:253], v[236:237], v[236:237] op_sel_hi:[1,0,0]
    v_rcp_f32 v246, v246
    v_rcp_f32 v247, v247
    s_add_u32 m0, s66, 147456
    s_add_u32 s77, s77, 32768
    buffer_load_dwordx4 v25, s[44:47], s77 offen offset:0 lds
    v_rcp_f32 v248, v248
    v_rcp_f32 v249, v249
    v_rcp_f32 v250, v250
    v_rcp_f32 v251, v251
    v_rcp_f32 v252, v252
    v_rcp_f32 v253, v253
    v_pk_mul_f32 v[246:247], v[246:247], v[98:99]
    v_pk_mul_f32 v[248:249], v[248:249], v[100:101]
    v_pk_mul_f32 v[250:251], v[250:251], v[102:103]
    v_pk_mul_f32 v[252:253], v[252:253], v[104:105]
    v_cvt_pk_bf16_f32 v98, v246, v247
    v_cvt_pk_bf16_f32 v99, v248, v249
    v_cvt_pk_bf16_f32 v100, v250, v251
    buffer_load_dwordx4 v26, s[44:47], s77 offen offset:1024 lds
    v_cvt_pk_bf16_f32 v101, v252, v253
    buffer_store_dwordx4 v[98:101], v20, s[48:51], s73 offen offset:0 sc1
    v_pk_mul_f32 v[246:247], v[106:107], v[106:107]
    v_pk_mul_f32 v[248:249], v[108:109], v[108:109]
    v_pk_mul_f32 v[250:251], v[110:111], v[110:111]
    v_pk_mul_f32 v[252:253], v[112:113], v[112:113]
    v_pk_fma_f32 v[246:247], v[246:247], v[234:235], v[234:235] op_sel:[0,1,0] op_sel_hi:[1,1,0]
    v_pk_fma_f32 v[248:249], v[248:249], v[234:235], v[234:235] op_sel:[0,1,0] op_sel_hi:[1,1,0]
    v_pk_fma_f32 v[250:251], v[250:251], v[234:235], v[234:235] op_sel:[0,1,0] op_sel_hi:[1,1,0]
    v_pk_fma_f32 v[252:253], v[252:253], v[234:235], v[234:235] op_sel:[0,1,0] op_sel_hi:[1,1,0]
    v_pk_mul_f32 v[246:247], v[246:247], v[106:107]
    v_pk_mul_f32 v[248:249], v[248:249], v[108:109]
    v_pk_mul_f32 v[250:251], v[250:251], v[110:111]
    buffer_load_dwordx4 v27, s[44:47], s77 offen offset:2048 lds
    v_pk_mul_f32 v[252:253], v[252:253], v[112:113]
    v_exp_f32 v246, v246
    v_exp_f32 v247, v247
    v_exp_f32 v248, v248
    v_exp_f32 v249, v249
    v_exp_f32 v250, v250
    v_exp_f32 v251, v251
    v_exp_f32 v252, v252
    v_exp_f32 v253, v253
    v_pk_fma_f32 v[246:247], v[246:247], v[236:237], v[236:237] op_sel_hi:[1,0,0]
    v_pk_fma_f32 v[248:249], v[248:249], v[236:237], v[236:237] op_sel_hi:[1,0,0]
    v_pk_fma_f32 v[250:251], v[250:251], v[236:237], v[236:237] op_sel_hi:[1,0,0]
    v_pk_fma_f32 v[252:253], v[252:253], v[236:237], v[236:237] op_sel_hi:[1,0,0]
    buffer_load_dwordx4 v28, s[44:47], s77 offen offset:3072 lds
    v_rcp_f32 v246, v246
    v_rcp_f32 v247, v247
    v_rcp_f32 v248, v248
    v_rcp_f32 v249, v249
    v_rcp_f32 v250, v250
    v_rcp_f32 v251, v251
    v_rcp_f32 v252, v252
    v_rcp_f32 v253, v253
    v_pk_mul_f32 v[246:247], v[246:247], v[106:107]
    v_pk_mul_f32 v[248:249], v[248:249], v[108:109]
    v_pk_mul_f32 v[250:251], v[250:251], v[110:111]
    v_pk_mul_f32 v[252:253], v[252:253], v[112:113]
    v_cvt_pk_bf16_f32 v106, v246, v247
    v_cvt_pk_bf16_f32 v107, v248, v249
    v_cvt_pk_bf16_f32 v108, v250, v251
    v_cvt_pk_bf16_f32 v109, v252, v253
    buffer_store_dwordx4 v[106:109], v20, s[48:51], s73 offen offset:1024 sc1
    v_pk_mul_f32 v[246:247], v[114:115], v[114:115]
    v_pk_mul_f32 v[248:249], v[116:117], v[116:117]
    v_pk_mul_f32 v[250:251], v[118:119], v[118:119]
    v_pk_mul_f32 v[252:253], v[120:121], v[120:121]
    v_pk_fma_f32 v[246:247], v[246:247], v[238:239], v[238:239] op_sel:[0,1,0] op_sel_hi:[1,1,0]
    v_pk_fma_f32 v[248:249], v[248:249], v[238:239], v[238:239] op_sel:[0,1,0] op_sel_hi:[1,1,0]
    v_pk_fma_f32 v[250:251], v[250:251], v[238:239], v[238:239] op_sel:[0,1,0] op_sel_hi:[1,1,0]
    v_pk_fma_f32 v[252:253], v[252:253], v[238:239], v[238:239] op_sel:[0,1,0] op_sel_hi:[1,1,0]
    v_pk_mul_f32 v[246:247], v[246:247], v[114:115]
    v_pk_mul_f32 v[248:249], v[248:249], v[116:117]
    v_pk_mul_f32 v[250:251], v[250:251], v[118:119]
    v_pk_mul_f32 v[252:253], v[252:253], v[120:121]
    v_exp_f32 v246, v246
    v_exp_f32 v247, v247
    v_exp_f32 v248, v248
    v_exp_f32 v249, v249
    v_exp_f32 v250, v250
    v_exp_f32 v251, v251
    v_exp_f32 v252, v252
    v_exp_f32 v253, v253
Lpg2:
    s_cbranch_execz Liw_ret
    v_pk_fma_f32 v[246:247], v[246:247], v[240:241], v[240:241] op_sel_hi:[1,0,0]
    v_pk_fma_f32 v[248:249], v[248:249], v[240:241], v[240:241] op_sel_hi:[1,0,0]
    v_pk_fma_f32 v[250:251], v[250:251], v[240:241], v[240:241] op_sel_hi:[1,0,0]
    v_pk_fma_f32 v[252:253], v[252:253], v[240:241], v[240:241] op_sel_hi:[1,0,0]
    v_rcp_f32 v246, v246
    v_rcp_f32 v247, v247
    v_rcp_f32 v248, v248
    v_rcp_f32 v249, v249
    v_rcp_f32 v250, v250
    v_rcp_f32 v251, v251
    v_rcp_f32 v252, v252
    v_rcp_f32 v253, v253
    v_pk_mul_f32 v[246:247], v[246:247], v[114:115]
    v_pk_mul_f32 v[248:249], v[248:249], v[116:117]
    v_pk_mul_f32 v[250:251], v[250:251], v[118:119]
    v_pk_mul_f32 v[252:253], v[252:253], v[120:121]
    v_cvt_pk_bf16_f32 v114, v246, v247
    v_cvt_pk_bf16_f32 v115, v248, v249
    v_cvt_pk_bf16_f32 v116, v250, v251
    v_cvt_pk_bf16_f32 v117, v252, v253
    buffer_store_dwordx4 v[114:117], v20, s[48:51], s67 offen offset:0 sc1
    v_pk_mul_f32 v[246:247], v[122:123], v[122:123]
    v_pk_mul_f32 v[248:249], v[124:125], v[124:125]
    v_pk_mul_f32 v[250:251], v[126:127], v[126:127]
    v_pk_mul_f32 v[252:253], v[128:129], v[128:129]
    v_pk_fma_f32 v[246:247], v[246:247], v[238:239], v[238:239] op_sel:[0,1,0] op_sel_hi:[1,1,0]
    v_pk_fma_f32 v[248:249], v[248:249], v[238:239], v[238:239] op_sel:[0,1,0] op_sel_hi:[1,1,0]
    v_pk_fma_f32 v[250:251], v[250:251], v[238:239], v[238:239] op_sel:[0,1,0] op_sel_hi:[1,1,0]
    v_pk_fma_f32 v[252:253], v[252:253], v[238:239], v[238:239] op_sel:[0,1,0] op_sel_hi:[1,1,0]
    v_pk_mul_f32 v[246:247], v[246:247], v[122:123]
    v_pk_mul_f32 v[248:249], v[248:249], v[124:125]
    v_pk_mul_f32 v[250:251], v[250:251], v[126:127]
    v_pk_mul_f32 v[252:253], v[252:253], v[128:129]
    v_exp_f32 v246, v246
    v_exp_f32 v247, v247
    v_exp_f32 v248, v248
    v_exp_f32 v249, v249
    v_exp_f32 v250, v250
    v_exp_f32 v251, v251
    v_exp_f32 v252, v252
    v_exp_f32 v253, v253
    v_pk_fma_f32 v[246:247], v[246:247], v[240:241], v[240:241] op_sel_hi:[1,0,0]
    v_pk_fma_f32 v[248:249], v[248:249], v[240:241], v[240:241] op_sel_hi:[1,0,0]
    v_pk_fma_f32 v[250:251], v[250:251], v[240:241], v[240:241] op_sel_hi:[1,0,0]
    v_pk_fma_f32 v[252:253], v[252:253], v[240:241], v[240:241] op_sel_hi:[1,0,0]
    v_rcp_f32 v246, v246
    v_rcp_f32 v247, v247
    v_rcp_f32 v248, v248
    v_rcp_f32 v249, v249
    v_rcp_f32 v250, v250
    v_rcp_f32 v251, v251
    v_rcp_f32 v252, v252
    v_rcp_f32 v253, v253
    v_pk_mul_f32 v[246:247], v[246:247], v[122:123]
    v_pk_mul_f32 v[248:249], v[248:249], v[124:125]
    v_pk_mul_f32 v[250:251], v[250:251], v[126:127]
    v_pk_mul_f32 v[252:253], v[252:253], v[128:129]
    v_cvt_pk_bf16_f32 v122, v246, v247
    v_cvt_pk_bf16_f32 v123, v248, v249
    v_cvt_pk_bf16_f32 v124, v250, v251
    v_cvt_pk_bf16_f32 v125, v252, v253
    buffer_store_dwordx4 v[122:125], v20, s[48:51], s67 offen offset:1024 sc1
    v_pk_mul_f32 v[246:247], v[130:131], v[130:131]
    v_pk_mul_f32 v[248:249], v[132:133], v[132:133]
    v_pk_mul_f32 v[250:251], v[134:135], v[134:135]
    v_pk_mul_f32 v[252:253], v[136:137], v[136:137]
    v_pk_fma_f32 v[246:247], v[246:247], v[242:243], v[242:243] op_sel:[0,1,0] op_sel_hi:[1,1,0]
    v_pk_fma_f32 v[248:249], v[248:249], v[242:243], v[242:243] op_sel:[0,1,0] op_sel_hi:[1,1,0]
    v_pk_fma_f32 v[250:251], v[250:251], v[242:243], v[242:243] op_sel:[0,1,0] op_sel_hi:[1,1,0]
    v_pk_fma_f32 v[252:253], v[252:253], v[242:243], v[242:243] op_sel:[0,1,0] op_sel_hi:[1,1,0]
    v_pk_mul_f32 v[246:247], v[246:247], v[130:131]
    v_pk_mul_f32 v[248:249], v[248:249], v[132:133]
    v_pk_mul_f32 v[250:251], v[250:251], v[134:135]
    v_pk_mul_f32 v[252:253], v[252:253], v[136:137]
    v_exp_f32 v246, v246
    v_exp_f32 v247, v247
    v_exp_f32 v248, v248
    v_exp_f32 v249, v249
    v_exp_f32 v250, v250
    v_exp_f32 v251, v251
    v_exp_f32 v252, v252
    v_exp_f32 v253, v253
    v_pk_fma_f32 v[246:247], v[246:247], v[244:245], v[244:245] op_sel_hi:[1,0,0]
    v_pk_fma_f32 v[248:249], v[248:249], v[244:245], v[244:245] op_sel_hi:[1,0,0]
    v_pk_fma_f32 v[250:251], v[250:251], v[244:245], v[244:245] op_sel_hi:[1,0,0]
    v_pk_fma_f32 v[252:253], v[252:253], v[244:245], v[244:245] op_sel_hi:[1,0,0]
    v_rcp_f32 v246, v246
    v_rcp_f32 v247, v247
    v_rcp_f32 v248, v248
    v_rcp_f32 v249, v249
    v_rcp_f32 v250, v250
    v_rcp_f32 v251, v251
    v_rcp_f32 v252, v252
    v_rcp_f32 v253, v253
    v_pk_mul_f32 v[246:247], v[246:247], v[130:131]
    v_pk_mul_f32 v[248:249], v[248:249], v[132:133]
    v_pk_mul_f32 v[250:251], v[250:251], v[134:135]
    v_pk_mul_f32 v[252:253], v[252:253], v[136:137]
    v_cvt_pk_bf16_f32 v130, v246, v247
    v_cvt_pk_bf16_f32 v131, v248, v249
    v_cvt_pk_bf16_f32 v132, v250, v251
    v_cvt_pk_bf16_f32 v133, v252, v253
    buffer_store_dwordx4 v[130:133], v20, s[48:51], s68 offen offset:0 sc1
    ds_write_b128 v73, v[218:221] offset:8320
    ds_write_b128 v73, v[214:217] offset:0
    ds_write_b128 v73, v[226:229] offset:24704
    v_pk_mul_f32 v[246:247], v[138:139], v[138:139]
    v_pk_mul_f32 v[248:249], v[140:141], v[140:141]
    v_pk_mul_f32 v[250:251], v[142:143], v[142:143]
    v_pk_mul_f32 v[252:253], v[144:145], v[144:145]
    v_pk_fma_f32 v[246:247], v[246:247], v[242:243], v[242:243] op_sel:[0,1,0] op_sel_hi:[1,1,0]
    v_pk_fma_f32 v[248:249], v[248:249], v[242:243], v[242:243] op_sel:[0,1,0] op_sel_hi:[1,1,0]
    v_pk_fma_f32 v[250:251], v[250:251], v[242:243], v[242:243] op_sel:[0,1,0] op_sel_hi:[1,1,0]
    v_pk_fma_f32 v[252:253], v[252:253], v[242:243], v[242:243] op_sel:[0,1,0] op_sel_hi:[1,1,0]
    v_pk_mul_f32 v[246:247], v[246:247], v[138:139]
    v_pk_mul_f32 v[248:249], v[248:249], v[140:141]
    v_pk_mul_f32 v[250:251], v[250:251], v[142:143]
    v_pk_mul_f32 v[252:253], v[252:253], v[144:145]
    v_exp_f32 v246, v246
    v_exp_f32 v247, v247
    v_exp_f32 v248, v248
    v_exp_f32 v249, v249
    v_exp_f32 v250, v250
    v_exp_f32 v251, v251
    v_exp_f32 v252, v252
    v_exp_f32 v253, v253
    v_pk_fma_f32 v[246:247], v[246:247], v[244:245], v[244:245] op_sel_hi:[1,0,0]
    v_pk_fma_f32 v[248:249], v[248:249], v[244:245], v[244:245] op_sel_hi:[1,0,0]
    v_pk_fma_f32 v[250:251], v[250:251], v[244:245], v[244:245] op_sel_hi:[1,0,0]
    v_pk_fma_f32 v[252:253], v[252:253], v[244:245], v[244:245] op_sel_hi:[1,0,0]
    v_rcp_f32 v246, v246
    v_rcp_f32 v247, v247
    v_rcp_f32 v248, v248
    v_rcp_f32 v249, v249
    v_rcp_f32 v250, v250
    v_rcp_f32 v251, v251
    v_rcp_f32 v252, v252
    v_rcp_f32 v253, v253
    v_pk_mul_f32 v[246:247], v[246:247], v[138:139]
    v_pk_mul_f32 v[248:249], v[248:249], v[140:141]
    v_pk_mul_f32 v[250:251], v[250:251], v[142:143]
    v_pk_mul_f32 v[252:253], v[252:253], v[144:145]
    v_cvt_pk_bf16_f32 v138, v246, v247
    v_cvt_pk_bf16_f32 v139, v248, v249
    v_cvt_pk_bf16_f32 v140, v250, v251
    v_cvt_pk_bf16_f32 v141, v252, v253
    buffer_store_dwordx4 v[138:141], v20, s[48:51], s68 offen offset:1024 sc1
    ds_write_b128 v73, v[222:225] offset:16384
    ds_write_b128 v74, v[16:19] offset:4096
    ds_write_b64 v39, v[16:17] offset:32768
Ljoin:
    s_waitcnt vmcnt(15)
    ds_write_b32 v40, v2 offset:33276
    s_waitcnt lgkmcnt(0)
    s_barrier
    ds_read_b64 v[124:125], v37 offset:3776
    ds_read_b64 v[126:127], v37 offset:3784
    ds_read_b128 v[156:159], v38 offset:192
    ds_read_b64 v[128:129], v37 offset:3264
    ds_read_b64 v[130:131], v37 offset:3272
    ds_read_b128 v[160:163], v38 offset:704
    ds_read_b64 v[132:133], v37 offset:2752
    ds_read_b64 v[134:135], v37 offset:2760
    ds_read_b128 v[164:167], v38 offset:1216
    ds_read_b64 v[136:137], v37 offset:2240
    s_waitcnt lgkmcnt(7)
    v_mfma_f32_16x16x32_bf16 a[224:227], v[124:127], v[156:159], 0
    ds_read_b64 v[138:139], v37 offset:2248
    s_waitcnt lgkmcnt(5)
    v_mfma_f32_16x16x32_bf16 a[228:231], v[124:127], v[160:163], 0
    ds_read_b128 v[168:171], v38 offset:1728
    ds_read_b64_tr_b16 a[48:49], v29 offset:49152
    v_mfma_f32_16x16x32_bf16 a[232:235], v[128:131], v[160:163], 0
    s_add_u32 m0, s66, 98304
    s_add_u32 s77, s77, 32768
    buffer_load_dwordx4 v25, s[44:47], s77 offen offset:0 lds
    v_mfma_f32_16x16x32_bf16 a[228:231], v[128:131], v[156:159], a[228:231]
    ds_read_b64_tr_b16 a[50:51], v29 offset:51200
    ds_read_b64_tr_b16 a[52:53], v30 offset:49152
    s_waitcnt lgkmcnt(6)
    v_mfma_f32_16x16x32_bf16 a[232:235], v[124:127], v[164:167], a[232:235]
    ds_read_b64_tr_b16 a[54:55], v30 offset:51200
    ds_read_b64_tr_b16 a[56:57], v31 offset:49152
    v_mfma_f32_16x16x32_bf16 a[236:239], v[128:131], v[164:167], 0
    ds_read_b64_tr_b16 a[58:59], v31 offset:51200
    ds_read_b64_tr_b16 a[60:61], v32 offset:49152
    v_mfma_f32_16x16x32_bf16 a[240:243], v[132:135], v[164:167], 0
    ds_read_b64 v[140:141], v37 offset:1728
    buffer_load_dwordx4 v26, s[44:47], s77 offen offset:1024 lds
    ds_read_b64_tr_b16 a[62:63], v32 offset:51200
    v_mfma_f32_16x16x32_bf16 a[236:239], v[132:135], v[160:163], a[236:239]
    ds_read_b64 v[142:143], v37 offset:1736
    ds_read_b64_tr_b16 a[64:65], v29 offset:0
    v_mfma_f32_16x16x32_bf16 a[232:235], v[132:135], v[156:159], a[232:235]
    ds_read_b128 v[172:175], v38 offset:2240
    ds_read_b64_tr_b16 a[66:67], v29 offset:2048
    s_waitcnt lgkmcnt(13)
    v_mfma_f32_16x16x32_bf16 a[236:239], v[124:127], v[168:171], a[236:239]
    ds_read_b64_tr_b16 a[68:69], v30 offset:0
    ds_read_b64_tr_b16 a[70:71], v30 offset:2048
    v_mfma_f32_16x16x32_bf16 a[240:243], v[128:131], v[168:171], a[240:243]
    buffer_load_dwordx4 v27, s[44:47], s77 offen offset:2048 lds
    ds_read_b64_tr_b16 a[72:73], v31 offset:0
    ds_read_b64_tr_b16 a[74:75], v31 offset:2048
    v_mfma_f32_16x16x32_bf16 a[244:247], v[132:135], v[168:171], 0
    ds_read_b64_tr_b16 a[76:77], v32 offset:0
    ds_read_b64_tr_b16 a[78:79], v32 offset:2048
    v_mfma_f32_16x16x32_bf16 a[248:251], v[136:139], v[168:171], 0
    ds_read_b64_tr_b16 a[80:81], v33 offset:0
    ds_read_b64_tr_b16 a[82:83], v33 offset:2048
    v_mfma_f32_16x16x32_bf16 a[244:247], v[136:139], v[164:167], a[244:247]
    ds_read_b64_tr_b16 a[84:85], v34 offset:0
    ds_read_b64_tr_b16 a[86:87], v34 offset:2048
    v_mfma_f32_16x16x32_bf16 a[240:243], v[136:139], v[160:163], a[240:243]
    ds_read_b64 v[144:145], v37 offset:1216
    buffer_load_dwordx4 v28, s[44:47], s77 offen offset:3072 lds
    ds_read_b64_tr_b16 a[88:89], v35 offset:0
    v_mfma_f32_16x16x32_bf16 a[236:239], v[136:139], v[156:159], a[236:239]
    ds_read_b64 v[146:147], v37 offset:1224
    ds_read_b64_tr_b16 a[90:91], v35 offset:2048
    s_waitcnt lgkmcnt(15)
    v_mfma_f32_16x16x32_bf16 a[240:243], v[124:127], v[172:175], a[240:243]
    ds_read_b128 v[176:179], v38 offset:2752
    ds_read_b64_tr_b16 a[92:93], v36 offset:0
    v_mfma_f32_16x16x32_bf16 a[244:247], v[128:131], v[172:175], a[244:247]
    ds_read_b64_tr_b16 a[94:95], v36 offset:2048
    v_mfma_f32_16x16x32_bf16 a[248:251], v[132:135], v[172:175], a[248:251]
    ds_read_b64 v[148:149], v37 offset:704
    s_add_u32 m0, s66, 114688
    s_add_u32 s77, s77, 32768
    buffer_load_dwordx4 v25, s[44:47], s77 offen offset:0 lds
    v_mfma_f32_16x16x32_bf16 a[252:255], v[136:139], v[172:175], 0
    ds_read_b64 v[150:151], v37 offset:712
    s_waitcnt vmcnt(9)
    ds_read_b64_tr_b16 a[96:97], v29 offset:16384
    v_mfma_f32_16x16x32_bf16 a[252:255], v[140:143], v[168:171], a[252:255]
    ds_read_b128 v[180:183], v38 offset:3264
    ds_read_b64_tr_b16 a[98:99], v29 offset:18432
    v_mfma_f32_16x16x32_bf16 a[248:251], v[140:143], v[164:167], a[248:251]
    ds_read_b64 v[152:153], v37 offset:192
    ds_read_b64_tr_b16 a[100:101], v30 offset:16384
    v_mfma_f32_16x16x32_bf16 a[244:247], v[140:143], v[160:163], a[244:247]
    ds_read_b64 v[154:155], v37 offset:200
    buffer_load_dwordx4 v26, s[44:47], s77 offen offset:1024 lds
    ds_read_b64_tr_b16 a[102:103], v30 offset:18432
    s_waitcnt vmcnt(6)
    s_atomic_swap s64, s[34:35], s74
    v_mfma_f32_16x16x32_bf16 a[240:243], v[140:143], v[156:159], a[240:243]
    ds_read_b128 v[184:187], v38 offset:3776
    ds_read_b64_tr_b16 a[104:105], v31 offset:16384
    s_waitcnt lgkmcnt(13)
    v_mfma_f32_16x16x32_bf16 a[244:247], v[124:127], v[176:179], a[244:247]
    ds_read_b64 v[188:189], v37 offset:3712
    ds_read_b64_tr_b16 a[106:107], v31 offset:18432
    v_mfma_f32_16x16x32_bf16 a[248:251], v[128:131], v[176:179], a[248:251]
    ds_read_b64 v[190:191], v37 offset:3720
    ds_read_b64_tr_b16 a[108:109], v32 offset:16384
    v_mfma_f32_16x16x32_bf16 a[252:255], v[132:135], v[176:179], a[252:255]
    ds_read_b128 v[220:223], v38 offset:128
    buffer_load_dwordx4 v27, s[44:47], s77 offen offset:2048 lds
    ds_read_b64_tr_b16 a[110:111], v32 offset:18432
    v_mfma_f32_16x16x32_bf16 a[252:255], v[144:147], v[164:167], a[252:255]
    ds_read_b64 v[192:193], v37 offset:3200
    ds_read_b64_tr_b16 a[112:113], v33 offset:16384
    v_mfma_f32_16x16x32_bf16 a[248:251], v[144:147], v[160:163], a[248:251]
    ds_read_b64 v[194:195], v37 offset:3208
    ds_read_b64_tr_b16 a[114:115], v33 offset:18432
    v_mfma_f32_16x16x32_bf16 a[244:247], v[144:147], v[156:159], a[244:247]
    ds_read_b128 v[224:227], v38 offset:640
    ds_read_b64_tr_b16 a[116:117], v34 offset:16384
    s_waitcnt lgkmcnt(15)
    v_mfma_f32_16x16x32_bf16 a[248:251], v[124:127], v[180:183], a[248:251]
    ds_read_b64 v[196:197], v37 offset:2688
    buffer_load_dwordx4 v28, s[44:47], s77 offen offset:3072 lds
    ds_read_b64_tr_b16 a[118:119], v34 offset:18432
    v_mfma_f32_16x16x32_bf16 a[252:255], v[128:131], v[180:183], a[252:255]
    ds_read_b64 v[198:199], v37 offset:2696
    ds_read_b64_tr_b16 a[120:121], v35 offset:16384
    v_mfma_f32_16x16x32_bf16 a[252:255], v[148:151], v[160:163], a[252:255]
    ds_read_b128 v[228:231], v38 offset:1152
    ds_read_b64_tr_b16 a[122:123], v35 offset:18432
    v_mfma_f32_16x16x32_bf16 a[248:251], v[148:151], v[156:159], a[248:251]
    ds_read_b64_tr_b16 a[124:125], v36 offset:16384
    ds_read_b64_tr_b16 a[126:127], v36 offset:18432
    s_waitcnt lgkmcnt(15)
    v_mfma_f32_16x16x32_bf16 a[252:255], v[124:127], v[184:187], a[252:255]
    s_add_u32 m0, s66, 65536
    s_add_u32 s77, s77, 32768
    buffer_load_dwordx4 v25, s[44:47], s77 offen offset:0 lds
    v_mfma_f32_16x16x32_bf16 a[252:255], v[152:155], v[156:159], a[252:255]
    ds_read_b64 v[200:201], v37 offset:2176
    v_mfma_f32_16x16x32_bf16 a[224:227], v[188:191], v[220:223], a[224:227]
    ds_read_b64 v[202:203], v37 offset:2184
    s_waitcnt lgkmcnt(11)
    v_mfma_f32_16x16x32_bf16 a[228:231], v[188:191], v[224:227], a[228:231]
    ds_read_b128 v[232:235], v38 offset:1664
    s_lshl2_add_u32 s63, s80, s58
    v_mfma_f32_16x16x32_bf16 a[232:235], v[192:195], v[224:227], a[232:235]
    buffer_load_dwordx4 v26, s[44:47], s77 offen offset:1024 lds
    s_lshl_b32 s15, s63, 7
    v_mfma_f32_16x16x32_bf16 a[228:231], v[192:195], v[220:223], a[228:231]
    s_add_u32 s17, s15, 589824
    s_waitcnt lgkmcnt(6)
    v_mfma_f32_16x16x32_bf16 a[232:235], v[188:191], v[228:231], a[232:235]
    s_lshl_b32 s15, s15, 0
    s_add_u32 s15, s15, 131072
    v_mfma_f32_16x16x32_bf16 a[236:239], v[192:195], v[228:231], a[236:239]
    s_lshl_b32 s62, s81, 7
    v_lshrrev_b32 v54, 2, v24
    v_mfma_f32_16x16x32_bf16 a[240:243], v[196:199], v[228:231], a[240:243]
    ds_read_b64 v[204:205], v37 offset:1664
    buffer_load_dwordx4 v27, s[44:47], s77 offen offset:2048 lds
    v_mfma_f32_16x16x32_bf16 a[236:239], v[196:199], v[224:227], a[236:239]
    ds_read_b64 v[206:207], v37 offset:1672
    v_add_u32 v54, s62, v54
    v_mfma_f32_16x16x32_bf16 a[232:235], v[196:199], v[220:223], a[232:235]
    ds_read_b128 v[236:239], v38 offset:2176
    s_waitcnt lgkmcnt(3)
    v_mfma_f32_16x16x32_bf16 a[236:239], v[188:191], v[232:235], a[236:239]
    v_lshlrev_b32 v55, 3, v4
    v_min_u32 v24, 6, v1
    v_mfma_f32_16x16x32_bf16 a[240:243], v[192:195], v[232:235], a[240:243]
    buffer_load_dwordx4 v28, s[44:47], s77 offen offset:3072 lds
    v_lshlrev_b32 v24, 2, v24
    v_mfma_f32_16x16x32_bf16 a[244:247], v[196:199], v[232:235], a[244:247]
    v_mfma_f32_16x16x32_bf16 a[248:251], v[200:203], v[232:235], a[248:251]
    v_mfma_f32_16x16x32_bf16 a[244:247], v[200:203], v[228:231], a[244:247]
    v_mfma_f32_16x16x32_bf16 a[240:243], v[200:203], v[224:227], a[240:243]
    ds_read_b64 v[208:209], v37 offset:1152
    v_mfma_f32_16x16x32_bf16 a[236:239], v[200:203], v[220:223], a[236:239]
    ds_read_b64 v[210:211], v37 offset:1160
    s_waitcnt lgkmcnt(2)
    v_mfma_f32_16x16x32_bf16 a[240:243], v[188:191], v[236:239], a[240:243]
    ds_read_b128 v[240:243], v38 offset:2688
    v_mfma_f32_16x16x32_bf16 a[244:247], v[192:195], v[236:239], a[244:247]
    s_add_u32 m0, s66, 131072
    s_add_u32 s77, s77, 32768
    buffer_load_dwordx4 v25, s[44:47], s77 offen offset:0 lds
    v_mfma_f32_16x16x32_bf16 a[248:251], v[196:199], v[236:239], a[248:251]
    ds_read_b64 v[212:213], v37 offset:640
    v_mfma_f32_16x16x32_bf16 a[252:255], v[200:203], v[236:239], a[252:255]
    ds_read_b64 v[214:215], v37 offset:648
    v_mfma_f32_16x16x32_bf16 a[252:255], v[204:207], v[232:235], a[252:255]
    ds_read_b128 v[244:247], v38 offset:3200
    v_mfma_f32_16x16x32_bf16 a[248:251], v[204:207], v[228:231], a[248:251]
    ds_read_b64 v[216:217], v37 offset:128
    buffer_load_dwordx4 v26, s[44:47], s77 offen offset:1024 lds
    v_mfma_f32_16x16x32_bf16 a[244:247], v[204:207], v[224:227], a[244:247]
    ds_read_b64 v[218:219], v37 offset:136
    s_waitcnt vmcnt(10)
    ds_read_b64_tr_b16 a[128:129], v29 offset:32768
    v_mfma_f32_16x16x32_bf16 a[240:243], v[204:207], v[220:223], a[240:243]
    ds_read_b128 v[248:251], v38 offset:3712
    ds_read_b64_tr_b16 a[130:131], v29 offset:34816
    s_waitcnt lgkmcnt(8)
    v_mfma_f32_16x16x32_bf16 a[244:247], v[188:191], v[240:243], a[244:247]
    ds_read_b64 v[124:125], v37 offset:3648
    ds_read_b64_tr_b16 a[132:133], v30 offset:32768
    s_lshl_b32 s20, s63, 14
    v_mfma_f32_16x16x32_bf16 a[248:251], v[192:195], v[240:243], a[248:251]
    ds_read_b64 v[126:127], v37 offset:3656
    buffer_load_dwordx4 v27, s[44:47], s77 offen offset:2048 lds
    ds_read_b64_tr_b16 a[134:135], v30 offset:34816
    v_mfma_f32_16x16x32_bf16 a[252:255], v[196:199], v[240:243], a[252:255]
    ds_read_b128 v[156:159], v38 offset:64
    ds_read_b64_tr_b16 a[136:137], v31 offset:32768
    v_mfma_f32_16x16x32_bf16 a[252:255], v[208:211], v[228:231], a[252:255]
    ds_read_b64 v[128:129], v37 offset:3136
    ds_read_b64_tr_b16 a[138:139], v31 offset:34816
    v_mfma_f32_16x16x32_bf16 a[248:251], v[208:211], v[224:227], a[248:251]
    ds_read_b64 v[130:131], v37 offset:3144
    ds_read_b64_tr_b16 a[140:141], v32 offset:32768
    v_mfma_f32_16x16x32_bf16 a[244:247], v[208:211], v[220:223], a[244:247]
    ds_read_b128 v[160:163], v38 offset:576
    buffer_load_dwordx4 v28, s[44:47], s77 offen offset:3072 lds
    s_waitcnt lgkmcnt(15)
    v_mfma_f32_16x16x32_bf16 a[248:251], v[188:191], v[244:247], a[248:251]
    ds_read_b64 v[132:133], v37 offset:2624
    ds_read_b64_tr_b16 a[142:143], v32 offset:34816
    s_add_u32 s20, s20, s62
    v_mfma_f32_16x16x32_bf16 a[252:255], v[192:195], v[244:247], a[252:255]
    ds_read_b64 v[134:135], v37 offset:2632
    buffer_load_dwordx2 v[66:67], v55, s[48:51], s17 offen sc1
    v_mfma_f32_16x16x32_bf16 a[252:255], v[212:215], v[224:227], a[252:255]
    ds_read_b128 v[164:167], v38 offset:1088
    v_add_u32 v21, 4096, v20
    s_add_u32 m0, s78, 7680
    v_mfma_f32_16x16x32_bf16 a[248:251], v[212:215], v[220:223], a[248:251]
    global_load_lds_dword v54, s[26:27]
    s_waitcnt lgkmcnt(15)
    v_mfma_f32_16x16x32_bf16 a[252:255], v[188:191], v[248:251], a[252:255]
    s_add_u32 m0, s66, 81920
    s_add_u32 s77, s77, 32768
    buffer_load_dwordx4 v25, s[44:47], s77 offen offset:0 lds
    v_mfma_f32_16x16x32_bf16 a[252:255], v[216:219], v[220:223], a[252:255]
    ds_read_b64 v[136:137], v37 offset:2112
    s_waitcnt lgkmcnt(11)
    v_mfma_f32_16x16x32_bf16 a[224:227], v[124:127], v[156:159], a[224:227]
    ds_read_b64 v[138:139], v37 offset:2120
    v_add_u32 v22, 8192, v20
    s_waitcnt lgkmcnt(6)
    v_mfma_f32_16x16x32_bf16 a[228:231], v[124:127], v[160:163], a[228:231]
    ds_read_b128 v[168:171], v38 offset:1600
    v_add_u32 v23, 12288, v20
    v_mfma_f32_16x16x32_bf16 a[232:235], v[128:131], v[160:163], a[232:235]
    buffer_load_dwordx4 v26, s[44:47], s77 offen offset:1024 lds
    s_waitcnt vmcnt(12)
    ds_read_b64_tr_b16 a[144:145], v29 offset:49152
    v_mfma_f32_16x16x32_bf16 a[228:231], v[128:131], v[156:159], a[228:231]
    ds_read_b64_tr_b16 a[146:147], v29 offset:51200
    ds_read_b64_tr_b16 a[148:149], v30 offset:49152
    s_waitcnt lgkmcnt(6)
    v_mfma_f32_16x16x32_bf16 a[232:235], v[124:127], v[164:167], a[232:235]
    ds_read_b64_tr_b16 a[150:151], v30 offset:51200
    ds_read_b64_tr_b16 a[152:153], v31 offset:49152
    v_mfma_f32_16x16x32_bf16 a[236:239], v[128:131], v[164:167], a[236:239]
    ds_read_b64_tr_b16 a[154:155], v31 offset:51200
    ds_read_b64_tr_b16 a[156:157], v32 offset:49152
    v_mfma_f32_16x16x32_bf16 a[240:243], v[132:135], v[164:167], a[240:243]
    ds_read_b64 v[140:141], v37 offset:1600
    buffer_load_dwordx4 v27, s[44:47], s77 offen offset:2048 lds
    ds_read_b64_tr_b16 a[158:159], v32 offset:51200
    v_mfma_f32_16x16x32_bf16 a[236:239], v[132:135], v[160:163], a[236:239]
    ds_read_b64 v[142:143], v37 offset:1608
    s_lshl4_add_u32 s63, s80, s58
    v_mfma_f32_16x16x32_bf16 a[232:235], v[132:135], v[156:159], a[232:235]
    ds_read_b128 v[172:175], v38 offset:2112
    buffer_load_dword v7, v24, s[48:51], s15 offen sc1
    s_waitcnt lgkmcnt(11)
    v_mfma_f32_16x16x32_bf16 a[236:239], v[124:127], v[168:171], a[236:239]
    s_mul_i32 s63, s63, 14336
    s_add_u32 s63, s63, 8388608
    s_add_u32 s62, s58, 1
    v_mfma_f32_16x16x32_bf16 a[240:243], v[128:131], v[168:171], a[240:243]
    buffer_load_dwordx4 v28, s[44:47], s77 offen offset:3072 lds
    s_and_b32 s62, s62, 3
    v_mfma_f32_16x16x32_bf16 a[244:247], v[132:135], v[168:171], a[244:247]
    s_mul_i32 s62, s62, 57344
    s_add_u32 s6, s62, s63
    v_mfma_f32_16x16x32_bf16 a[248:251], v[136:139], v[168:171], a[248:251]
    s_add_u32 s62, s58, 2
    s_and_b32 s62, s62, 3
    v_mfma_f32_16x16x32_bf16 a[244:247], v[136:139], v[164:167], a[244:247]
    s_mul_i32 s62, s62, 57344
    s_add_u32 s7, s62, s63
    v_mfma_f32_16x16x32_bf16 a[240:243], v[136:139], v[160:163], a[240:243]
    ds_read_b64 v[144:145], v37 offset:1088
    s_add_u32 m0, s66, 147456
    s_add_u32 s77, s77, 32768
    buffer_load_dwordx4 v25, s[44:47], s77 offen offset:0 lds
    v_mfma_f32_16x16x32_bf16 a[236:239], v[136:139], v[156:159], a[236:239]
    ds_read_b64 v[146:147], v37 offset:1096
    s_add_u32 s62, s58, 3
    s_waitcnt lgkmcnt(2)
    v_mfma_f32_16x16x32_bf16 a[240:243], v[124:127], v[172:175], a[240:243]
    ds_read_b128 v[176:179], v38 offset:2624
    s_and_b32 s62, s62, 3
    v_mfma_f32_16x16x32_bf16 a[244:247], v[128:131], v[172:175], a[244:247]
    ds_read_b64 v[148:149], v37 offset:576
    s_mul_i32 s62, s62, 57344
    v_mfma_f32_16x16x32_bf16 a[248:251], v[132:135], v[172:175], a[248:251]
    ds_read_b64 v[150:151], v37 offset:584
    buffer_load_dwordx4 v26, s[44:47], s77 offen offset:1024 lds
    v_mfma_f32_16x16x32_bf16 a[252:255], v[136:139], v[172:175], a[252:255]
    ds_read_b128 v[180:183], v38 offset:3136
    s_add_u32 s8, s62, s63
    v_mfma_f32_16x16x32_bf16 a[252:255], v[140:143], v[168:171], a[252:255]
    ds_read_b64 v[152:153], v37 offset:64
    s_mul_i32 s62, s58, 57344
    s_add_u32 s9, s62, s63
    v_mfma_f32_16x16x32_bf16 a[248:251], v[140:143], v[164:167], a[248:251]
    ds_read_b64 v[154:155], v37 offset:72
    v_xor_b32 v12, v1, v5
    v_mfma_f32_16x16x32_bf16 a[244:247], v[140:143], v[160:163], a[244:247]
    ds_read_b128 v[184:187], v38 offset:3648
    buffer_load_dwordx4 v27, s[44:47], s77 offen offset:2048 lds
    v_mfma_f32_16x16x32_bf16 a[240:243], v[140:143], v[156:159], a[240:243]
    ds_read_b64 v[188:189], v37 offset:3584
    s_waitcnt lgkmcnt(7)
    v_mfma_f32_16x16x32_bf16 a[244:247], v[124:127], v[176:179], a[244:247]
    ds_read_b64 v[190:191], v37 offset:3592
    s_add_u32 s62, s66, 98304
    v_mfma_f32_16x16x32_bf16 a[248:251], v[128:131], v[176:179], a[248:251]
    ds_read_b128 v[220:223], v38 offset:0
    v_lshl_add_u32 v41, v12, 4, s62
    v_and_b32 v12, 3, v1
    v_mfma_f32_16x16x32_bf16 a[252:255], v[132:135], v[176:179], a[252:255]
    ds_read_b64 v[192:193], v37 offset:3072
    buffer_load_dwordx4 v28, s[44:47], s77 offen offset:3072 lds
    v_mfma_f32_16x16x32_bf16 a[252:255], v[144:147], v[164:167], a[252:255]
    ds_read_b64 v[194:195], v37 offset:3080
    v_bfe_u32 v13, v1, 2, 3
    v_mfma_f32_16x16x32_bf16 a[248:251], v[144:147], v[160:163], a[248:251]
    ds_read_b128 v[224:227], v38 offset:512
    v_lshlrev_b32 v13, 1, v13
    v_mfma_f32_16x16x32_bf16 a[244:247], v[144:147], v[156:159], a[244:247]
    ds_read_b64 v[196:197], v37 offset:2560
    s_waitcnt lgkmcnt(10)
    v_mfma_f32_16x16x32_bf16 a[248:251], v[124:127], v[180:183], a[248:251]
    ds_read_b64 v[198:199], v37 offset:2568
    v_xor_b32 v13, v13, v12
    v_lshl_add_u32 v13, v12, 4, v13
    v_mfma_f32_16x16x32_bf16 a[252:255], v[128:131], v[180:183], a[252:255]
    ds_read_b128 v[228:231], v38 offset:1024
    v_lshrrev_b32 v12, 5, v1
    v_mfma_f32_16x16x32_bf16 a[252:255], v[148:151], v[160:163], a[252:255]
    ds_read_b64 v[200:201], v37 offset:2048
    v_lshl_add_u32 v13, v12, 6, v13
    v_mfma_f32_16x16x32_bf16 a[248:251], v[148:151], v[156:159], a[248:251]
    ds_read_b64 v[202:203], v37 offset:2056
    s_waitcnt lgkmcnt(11)
    v_mfma_f32_16x16x32_bf16 a[252:255], v[124:127], v[184:187], a[252:255]
    ds_read_b128 v[232:235], v38 offset:1536
    s_and_b32 s62, s58, 2
    v_mfma_f32_16x16x32_bf16 a[252:255], v[152:155], v[156:159], a[252:255]
    s_lshl2_add_u32 s62, s59, s62
    s_lshl_b32 s62, s62, 12
    s_waitcnt lgkmcnt(9)
    v_mfma_f32_16x16x32_bf16 a[224:227], v[188:191], v[220:223], a[224:227]
    ds_read_b64 v[204:205], v37 offset:1536
    s_waitcnt lgkmcnt(7)
    v_mfma_f32_16x16x32_bf16 a[228:231], v[188:191], v[224:227], a[228:231]
    ds_read_b64 v[206:207], v37 offset:1544
    s_add_u32 s62, s62, 98304
    v_mfma_f32_16x16x32_bf16 a[228:231], v[192:195], v[220:223], a[228:231]
    ds_read_b128 v[236:239], v38 offset:2048
    s_waitcnt lgkmcnt(6)
    v_mfma_f32_16x16x32_bf16 a[232:235], v[188:191], v[228:231], a[232:235]
    v_lshl_add_u32 v42, v13, 4, s62
    v_xor_b32 v43, 16, v42
    v_mfma_f32_16x16x32_bf16 a[232:235], v[192:195], v[224:227], a[232:235]
    v_and_b32 v12, 0x380, v20
    v_add_u32 v57, v20, v12
    s_lshl1_add_u32 s14, s82, s59
    v_mfma_f32_16x16x32_bf16 a[232:235], v[196:199], v[220:223], a[232:235]
    ds_read_b64 v[208:209], v37 offset:1024
    s_waitcnt lgkmcnt(4)
    v_mfma_f32_16x16x32_bf16 a[236:239], v[188:191], v[232:235], a[236:239]
    ds_read_b64 v[210:211], v37 offset:1032
    s_lshl_b32 s14, s14, 12
    v_mfma_f32_16x16x32_bf16 a[236:239], v[192:195], v[228:231], a[236:239]
    ds_read_b128 v[240:243], v38 offset:2560
    s_add_u32 s14, s14, 4194304
    v_mfma_f32_16x16x32_bf16 a[236:239], v[196:199], v[224:227], a[236:239]
    s_waitcnt vmcnt(5)
    v_cmp_ne_u32 vcc, s64, v7
    s_cbranch_vccnz Lretry7
Lback7:
    v_mfma_f32_16x16x32_bf16 a[236:239], v[200:203], v[220:223], a[236:239]
    buffer_load_dwordx4 v[68:71], v20, s[48:51], s6 offen offset:0 sc1
    s_waitcnt lgkmcnt(3)
    v_mfma_f32_16x16x32_bf16 a[240:243], v[188:191], v[236:239], a[240:243]
    v_mfma_f32_16x16x32_bf16 a[240:243], v[192:195], v[232:235], a[240:243]
    ds_read_b64 v[212:213], v37 offset:512
    v_mfma_f32_16x16x32_bf16 a[240:243], v[196:199], v[228:231], a[240:243]
    ds_read_b64 v[214:215], v37 offset:520
    buffer_load_dwordx4 v[72:75], v20, s[48:51], s6 offen offset:1024 sc1
    v_mfma_f32_16x16x32_bf16 a[240:243], v[200:203], v[224:227], a[240:243]
    ds_read_b128 v[244:247], v38 offset:3072
    v_mfma_f32_16x16x32_bf16 a[240:243], v[204:207], v[220:223], a[240:243]
    s_waitcnt lgkmcnt(3)
    v_mfma_f32_16x16x32_bf16 a[244:247], v[188:191], v[240:243], a[244:247]
    buffer_load_dwordx4 v[76:79], v20, s[48:51], s6 offen offset:2048 sc1
    v_mfma_f32_16x16x32_bf16 a[244:247], v[192:195], v[236:239], a[244:247]
    v_mfma_f32_16x16x32_bf16 a[244:247], v[196:199], v[232:235], a[244:247]
    v_mfma_f32_16x16x32_bf16 a[244:247], v[200:203], v[228:231], a[244:247]
    ds_read_b64 v[216:217], v37 offset:0
    buffer_load_dwordx4 v[80:83], v20, s[48:51], s6 offen offset:3072 sc1
    v_mfma_f32_16x16x32_bf16 a[244:247], v[204:207], v[224:227], a[244:247]
    ds_read_b64 v[218:219], v37 offset:8
    v_mfma_f32_16x16x32_bf16 a[244:247], v[208:211], v[220:223], a[244:247]
    ds_read_b128 v[248:251], v38 offset:3584
    s_waitcnt lgkmcnt(3)
    v_mfma_f32_16x16x32_bf16 a[248:251], v[188:191], v[244:247], a[248:251]
    ds_write_b128 v41, a[224:227] offset:0
    buffer_load_dwordx4 v[84:87], v21, s[48:51], s6 offen offset:0 sc1
    v_mfma_f32_16x16x32_bf16 a[248:251], v[192:195], v[240:243], a[248:251]
    v_mfma_f32_16x16x32_bf16 a[248:251], v[196:199], v[236:239], a[248:251]
    ds_write_b128 v41, a[228:231] offset:1024
Lpg3:
    s_cbranch_execz Liw_ret
    v_mfma_f32_16x16x32_bf16 a[248:251], v[200:203], v[232:235], a[248:251]
    buffer_load_dwordx4 v[88:91], v21, s[48:51], s6 offen offset:1024 sc1
    v_mfma_f32_16x16x32_bf16 a[248:251], v[204:207], v[228:231], a[248:251]
    ds_write_b128 v41, a[232:235] offset:2048
    v_mfma_f32_16x16x32_bf16 a[248:251], v[208:211], v[224:227], a[248:251]
    v_mfma_f32_16x16x32_bf16 a[248:251], v[212:215], v[220:223], a[248:251]
    ds_write_b128 v41, a[236:239] offset:3072
    s_waitcnt lgkmcnt(4)
    v_mfma_f32_16x16x32_bf16 a[252:255], v[188:191], v[248:251], a[252:255]
    buffer_load_dwordx4 v[92:95], v21, s[48:51], s6 offen offset:2048 sc1
    v_mfma_f32_16x16x32_bf16 a[252:255], v[192:195], v[244:247], a[252:255]
    ds_write_b128 v41, a[240:243] offset:16384
    v_mfma_f32_16x16x32_bf16 a[252:255], v[196:199], v[240:243], a[252:255]
    v_mfma_f32_16x16x32_bf16 a[252:255], v[200:203], v[236:239], a[252:255]
    ds_write_b128 v41, a[244:247] offset:17408
    buffer_load_dwordx4 v[96:99], v21, s[48:51], s6 offen offset:3072 sc1
    v_mfma_f32_16x16x32_bf16 a[252:255], v[204:207], v[232:235], a[252:255]
    v_mfma_f32_16x16x32_bf16 a[252:255], v[208:211], v[228:231], a[252:255]
    v_mfma_f32_16x16x32_bf16 a[252:255], v[212:215], v[224:227], a[252:255]
    ds_write_b128 v41, a[248:251] offset:18432
    buffer_load_dwordx4 v[100:103], v22, s[48:51], s6 offen offset:0 sc1
    v_mfma_f32_16x16x32_bf16 a[252:255], v[216:219], v[220:223], a[252:255]
    v_mov_b32 v214, s64
    v_mov_b32 v215, s64
    v_mov_b32 v218, s64
    v_mov_b32 v219, s64
    v_mov_b32 v222, s64
    v_mov_b32 v223, s64
    v_mov_b32 v226, s64
    v_mov_b32 v227, s64
    ds_write_b128 v41, a[252:255] offset:19456
    buffer_load_dwordx4 v[104:107], v22, s[48:51], s6 offen offset:1024 sc1
    buffer_load_dwordx4 v[108:111], v22, s[48:51], s6 offen offset:2048 sc1
    buffer_load_dwordx4 v[112:115], v22, s[48:51], s6 offen offset:3072 sc1
    s_waitcnt lgkmcnt(0)
    s_barrier
    ds_read_b128 v[180:183], v42 offset:0
    ds_read_b128 v[184:187], v42 offset:4096
    ds_read_b128 v[188:191], v43 offset:0
    ds_read_b128 v[192:195], v43 offset:4096
    ds_read_b128 v[196:199], v42 offset:2048
    ds_read_b128 v[200:203], v42 offset:6144
    ds_read_b128 v[204:207], v43 offset:2048
    ds_read_b128 v[208:211], v43 offset:6144
    buffer_load_dwordx4 v[116:119], v23, s[48:51], s6 offen offset:0 sc1
    buffer_load_dwordx4 v[120:123], v23, s[48:51], s6 offen offset:1024 sc1
    buffer_load_dwordx4 v[124:127], v20, s[48:51], s7 offen offset:0 sc1
    s_waitcnt lgkmcnt(6)
    v_pk_add_f32 v[180:181], v[180:181], v[184:185]
    v_pk_add_f32 v[182:183], v[182:183], v[186:187]
    s_waitcnt lgkmcnt(4)
    v_pk_add_f32 v[188:189], v[188:189], v[192:193]
    v_pk_add_f32 v[190:191], v[190:191], v[194:195]
    v_cvt_pk_bf16_f32 v212, v188, v189
    v_cvt_pk_bf16_f32 v213, v180, v181
    v_cvt_pk_bf16_f32 v216, v190, v191
    v_cvt_pk_bf16_f32 v217, v182, v183
    s_waitcnt lgkmcnt(2)
    v_pk_add_f32 v[196:197], v[196:197], v[200:201]
    v_pk_add_f32 v[198:199], v[198:199], v[202:203]
    s_waitcnt lgkmcnt(0)
    v_pk_add_f32 v[204:205], v[204:205], v[208:209]
    v_pk_add_f32 v[206:207], v[206:207], v[210:211]
    v_cvt_pk_bf16_f32 v220, v204, v205
    v_cvt_pk_bf16_f32 v221, v196, v197
    v_cvt_pk_bf16_f32 v224, v206, v207
    v_cvt_pk_bf16_f32 v225, v198, v199
    buffer_load_dwordx4 v[128:131], v20, s[48:51], s7 offen offset:1024 sc1
    buffer_load_dwordx4 v[132:135], v20, s[48:51], s7 offen offset:2048 sc1
    buffer_store_dwordx4 v[212:215], v57, s[48:51], s14 offen offset:0 sc1
    buffer_store_dwordx4 v[216:219], v57, s[48:51], s14 offen offset:128 sc1
    buffer_store_dwordx4 v[220:223], v57, s[48:51], s14 offen offset:2048 sc1
    buffer_store_dwordx4 v[224:227], v57, s[48:51], s14 offen offset:2176 sc1
    s_waitcnt vmcnt(20)
    v_mfma_f32_16x16x32_bf16 v[180:183], a[0:3], v[68:71], 0
    ds_read_b64_tr_b16 a[160:161], v29 offset:0
    v_mfma_f32_16x16x32_bf16 v[184:187], a[4:7], v[68:71], 0
    ds_read_b64_tr_b16 a[162:163], v29 offset:2048
    s_add_u32 s62, s66, 65536
    v_mfma_f32_16x16x32_bf16 v[188:191], a[8:11], v[68:71], 0
    ds_read_b64_tr_b16 a[164:165], v30 offset:0
    v_add_u32 v46, s62, v20
    v_mfma_f32_16x16x32_bf16 v[192:195], a[12:15], v[68:71], 0
    ds_read_b64_tr_b16 a[166:167], v30 offset:2048
    s_waitcnt vmcnt(19)
    v_mfma_f32_16x16x32_bf16 v[180:183], a[16:19], v[72:75], v[180:183]
    ds_read_b64_tr_b16 a[168:169], v31 offset:0
    v_lshl_add_u32 v54, v5, 3, s78
    v_mfma_f32_16x16x32_bf16 v[184:187], a[20:23], v[72:75], v[184:187]
    ds_read_b64_tr_b16 a[170:171], v31 offset:2048
    v_mfma_f32_16x16x32_bf16 v[188:191], a[24:27], v[72:75], v[188:191]
    ds_read_b64_tr_b16 a[172:173], v32 offset:0
    v_mfma_f32_16x16x32_bf16 v[192:195], a[28:31], v[72:75], v[192:195]
    ds_read_b64_tr_b16 a[174:175], v32 offset:2048
    s_waitcnt vmcnt(18)
    v_mfma_f32_16x16x32_bf16 v[180:183], a[32:35], v[76:79], v[180:183]
    ds_read_b64_tr_b16 a[176:177], v33 offset:0
    v_mfma_f32_16x16x32_bf16 v[184:187], a[36:39], v[76:79], v[184:187]
    ds_read_b64_tr_b16 a[178:179], v33 offset:2048
    v_mfma_f32_16x16x32_bf16 v[188:191], a[40:43], v[76:79], v[188:191]
    ds_read_b64_tr_b16 a[180:181], v34 offset:0
    v_mfma_f32_16x16x32_bf16 v[192:195], a[44:47], v[76:79], v[192:195]
    ds_read_b64_tr_b16 a[182:183], v34 offset:2048
    s_waitcnt vmcnt(17)
    v_mfma_f32_16x16x32_bf16 v[180:183], a[48:51], v[80:83], v[180:183]
    ds_read_b64_tr_b16 a[184:185], v35 offset:0
    v_mfma_f32_16x16x32_bf16 v[184:187], a[52:55], v[80:83], v[184:187]
    ds_read_b64_tr_b16 a[186:187], v35 offset:2048
    v_mfma_f32_16x16x32_bf16 v[188:191], a[56:59], v[80:83], v[188:191]
    ds_read_b64_tr_b16 a[188:189], v36 offset:0
    v_mfma_f32_16x16x32_bf16 v[192:195], a[60:63], v[80:83], v[192:195]
    ds_read_b64_tr_b16 a[190:191], v36 offset:2048
    s_waitcnt vmcnt(16)
    v_mfma_f32_16x16x32_bf16 v[180:183], a[64:67], v[84:87], v[180:183]
    ds_read_b64_tr_b16 a[192:193], v29 offset:16384
    v_mfma_f32_16x16x32_bf16 v[184:187], a[68:71], v[84:87], v[184:187]
    ds_read_b64_tr_b16 a[194:195], v29 offset:18432
    v_mfma_f32_16x16x32_bf16 v[188:191], a[72:75], v[84:87], v[188:191]
    ds_read_b64_tr_b16 a[196:197], v30 offset:16384
    v_mfma_f32_16x16x32_bf16 v[192:195], a[76:79], v[84:87], v[192:195]
    ds_read_b64_tr_b16 a[198:199], v30 offset:18432
    s_waitcnt vmcnt(15)
    v_mfma_f32_16x16x32_bf16 v[180:183], a[80:83], v[88:91], v[180:183]
    ds_read_b64_tr_b16 a[200:201], v31 offset:16384
    v_mfma_f32_16x16x32_bf16 v[184:187], a[84:87], v[88:91], v[184:187]
    ds_read_b64_tr_b16 a[202:203], v31 offset:18432
    v_mfma_f32_16x16x32_bf16 v[188:191], a[88:91], v[88:91], v[188:191]
    ds_read_b64_tr_b16 a[204:205], v32 offset:16384
    v_mfma_f32_16x16x32_bf16 v[192:195], a[92:95], v[88:91], v[192:195]
    ds_read_b64_tr_b16 a[206:207], v32 offset:18432
    s_waitcnt vmcnt(14)
    v_mfma_f32_16x16x32_bf16 v[180:183], a[96:99], v[92:95], v[180:183]
    buffer_load_dwordx4 v[136:139], v20, s[48:51], s7 offen offset:3072 sc1
    v_mfma_f32_16x16x32_bf16 v[184:187], a[100:103], v[92:95], v[184:187]
    ds_read_b64_tr_b16 a[208:209], v33 offset:16384
    v_mfma_f32_16x16x32_bf16 v[188:191], a[104:107], v[92:95], v[188:191]
    ds_read_b64_tr_b16 a[210:211], v33 offset:18432
    v_mfma_f32_16x16x32_bf16 v[192:195], a[108:111], v[92:95], v[192:195]
    ds_read_b64_tr_b16 a[212:213], v34 offset:16384
    s_waitcnt vmcnt(14)
    v_mfma_f32_16x16x32_bf16 v[180:183], a[112:115], v[96:99], v[180:183]
    buffer_load_dwordx4 v[140:143], v21, s[48:51], s7 offen offset:0 sc1
    ds_read_b64_tr_b16 a[214:215], v34 offset:18432
    v_mfma_f32_16x16x32_bf16 v[184:187], a[116:119], v[96:99], v[184:187]
    ds_read_b64_tr_b16 a[216:217], v35 offset:16384
    v_mfma_f32_16x16x32_bf16 v[188:191], a[120:123], v[96:99], v[188:191]
    ds_read_b64_tr_b16 a[218:219], v35 offset:18432
    v_mfma_f32_16x16x32_bf16 v[192:195], a[124:127], v[96:99], v[192:195]
    ds_read_b64_tr_b16 a[220:221], v36 offset:16384
    s_waitcnt vmcnt(14)
    v_mfma_f32_16x16x32_bf16 v[180:183], a[128:131], v[100:103], v[180:183]
    buffer_load_dwordx4 v[144:147], v21, s[48:51], s7 offen offset:1024 sc1
    ds_read_b64_tr_b16 a[222:223], v36 offset:18432
    v_mfma_f32_16x16x32_bf16 v[184:187], a[132:135], v[100:103], v[184:187]
    v_mfma_f32_16x16x32_bf16 v[188:191], a[136:139], v[100:103], v[188:191]
    v_mfma_f32_16x16x32_bf16 v[192:195], a[140:143], v[100:103], v[192:195]
    s_waitcnt vmcnt(14)
    v_mfma_f32_16x16x32_bf16 v[180:183], a[144:147], v[104:107], v[180:183]
    buffer_load_dwordx4 v[148:151], v21, s[48:51], s7 offen offset:2048 sc1
    v_mfma_f32_16x16x32_bf16 v[184:187], a[148:151], v[104:107], v[184:187]
    v_mfma_f32_16x16x32_bf16 v[188:191], a[152:155], v[104:107], v[188:191]
    v_mfma_f32_16x16x32_bf16 v[192:195], a[156:159], v[104:107], v[192:195]
    s_waitcnt vmcnt(14) lgkmcnt(15)
    v_mfma_f32_16x16x32_bf16 v[180:183], a[160:163], v[108:111], v[180:183]
    buffer_load_dwordx4 v[152:155], v21, s[48:51], s7 offen offset:3072 sc1
    s_lshl2_add_u32 s60, s81, s58
    v_mfma_f32_16x16x32_bf16 v[184:187], a[164:167], v[108:111], v[184:187]
    s_lshl_b32 s60, s60, 9
    s_add_u32 s60, s60, s80
    v_mfma_f32_16x16x32_bf16 v[188:191], a[168:171], v[108:111], v[188:191]
    s_lshl_b32 s60, s60, 8
    s_add_u32 s92, s60, 4194304
    v_mfma_f32_16x16x32_bf16 v[192:195], a[172:175], v[108:111], v[192:195]
    s_add_u32 s93, s92, 32768
    s_waitcnt vmcnt(14)
    v_mfma_f32_16x16x32_bf16 v[180:183], a[176:179], v[112:115], v[180:183]
    buffer_load_dwordx4 v[156:159], v22, s[48:51], s7 offen offset:0 sc1
    s_add_u32 s94, s92, 65536
    v_mfma_f32_16x16x32_bf16 v[184:187], a[180:183], v[112:115], v[184:187]
    ds_read_b64 v[58:59], v54 offset:7680
    v_mfma_f32_16x16x32_bf16 v[188:191], a[184:187], v[112:115], v[188:191]
    ds_read_b64 v[60:61], v54 offset:7712
    s_add_u32 s95, s92, 98304
    v_mfma_f32_16x16x32_bf16 v[192:195], a[188:191], v[112:115], v[192:195]
    ds_read_b64 v[62:63], v54 offset:7744
    s_waitcnt vmcnt(14) lgkmcnt(15)
    v_mfma_f32_16x16x32_bf16 v[180:183], a[192:195], v[116:119], v[180:183]
    buffer_load_dwordx4 v[160:163], v22, s[48:51], s7 offen offset:1024 sc1
    ds_read_b64 v[64:65], v54 offset:7776
    v_mfma_f32_16x16x32_bf16 v[184:187], a[196:199], v[116:119], v[184:187]
    v_lshlrev_b32 v12, 13, v5
    v_lshl_add_u32 v56, v4, 4, v12
    s_waitcnt lgkmcnt(14)
    v_mfma_f32_16x16x32_bf16 v[188:191], a[200:203], v[116:119], v[188:191]
    s_sub_u32 s60, s66, 4096
    s_and_b32 s60, s60, 0x3000
    s_waitcnt lgkmcnt(12)
    v_mfma_f32_16x16x32_bf16 v[192:195], a[204:207], v[116:119], v[192:195]
    s_add_u32 s60, s60, 65536
    s_waitcnt vmcnt(14) lgkmcnt(10)
    v_mfma_f32_16x16x32_bf16 v[180:183], a[208:211], v[120:123], v[180:183]
    buffer_load_dwordx4 v[164:167], v22, s[48:51], s7 offen offset:2048 sc1
    v_add_u32 v8, s60, v20
    s_waitcnt lgkmcnt(8)
    v_mfma_f32_16x16x32_bf16 v[184:187], a[212:215], v[120:123], v[184:187]
    s_sub_u32 s60, s66, 8192
    s_and_b32 s60, s60, 0x3000
    s_waitcnt lgkmcnt(6)
    v_mfma_f32_16x16x32_bf16 v[188:191], a[216:219], v[120:123], v[188:191]
    s_add_u32 s60, s60, 81920
    v_add_u32 v9, s60, v20
    s_waitcnt lgkmcnt(4)
    v_mfma_f32_16x16x32_bf16 v[192:195], a[220:223], v[120:123], v[192:195]
    s_sub_u32 s60, s66, 12288
    s_waitcnt vmcnt(14)
    v_mfma_f32_16x16x32_bf16 v[196:199], a[0:3], v[124:127], 0
    buffer_load_dwordx4 v[168:171], v22, s[48:51], s7 offen offset:3072 sc1
    s_and_b32 s60, s60, 0x3000
    v_mfma_f32_16x16x32_bf16 v[200:203], a[4:7], v[124:127], 0
    s_add_u32 s60, s60, 98304
    v_add_u32 v10, s60, v20
    v_mfma_f32_16x16x32_bf16 v[204:207], a[8:11], v[124:127], 0
    v_bfe_u32 v12, v1, 1, 2
    v_lshrrev_b32 v13, 5, v1
    v_mfma_f32_16x16x32_bf16 v[208:211], a[12:15], v[124:127], 0
    v_xor_b32 v12, v12, v13
    s_waitcnt vmcnt(14)
    v_mfma_f32_16x16x32_bf16 v[196:199], a[16:19], v[128:131], v[196:199]
    buffer_load_dwordx4 v[172:175], v23, s[48:51], s7 offen offset:0 sc1
    v_lshlrev_b32 v12, 5, v12
    v_mfma_f32_16x16x32_bf16 v[200:203], a[20:23], v[128:131], v[200:203]
    ds_write_b128 v46, v[180:183] offset:0
    v_lshl_add_u32 v12, v5, 7, v12
    v_and_b32 v13, 1, v1
    v_mfma_f32_16x16x32_bf16 v[204:207], a[24:27], v[128:131], v[204:207]
    v_lshl_add_u32 v12, v13, 4, v12
    v_and_b32 v13, 8, v1
    v_mfma_f32_16x16x32_bf16 v[208:211], a[28:31], v[128:131], v[208:211]
    s_add_u32 s62, s66, 114688
    s_waitcnt vmcnt(14)
    v_mfma_f32_16x16x32_bf16 v[196:199], a[32:35], v[132:135], v[196:199]
    buffer_load_dwordx4 v[176:179], v23, s[48:51], s7 offen offset:1024 sc1
    v_add3_u32 v44, v12, v13, s62
    v_mfma_f32_16x16x32_bf16 v[200:203], a[36:39], v[132:135], v[200:203]
    ds_write_b128 v46, v[184:187] offset:1024
    v_xor_b32 v45, 64, v44
    v_and_b32 v13, 7, v1
    v_mfma_f32_16x16x32_bf16 v[204:207], a[40:43], v[132:135], v[204:207]
    v_lshrrev_b32 v14, 3, v1
    v_lshlrev_b32 v53, 10, v14
    v_mfma_f32_16x16x32_bf16 v[208:211], a[44:47], v[132:135], v[208:211]
    v_lshl_add_u32 v53, v13, 4, v53
    s_waitcnt vmcnt(10)
    v_mfma_f32_16x16x32_bf16 v[196:199], a[48:51], v[136:139], v[196:199]
    buffer_load_dwordx4 v[68:71], v20, s[48:51], s8 offen offset:0 sc1
    v_xor_b32 v12, v1, v14
    v_mfma_f32_16x16x32_bf16 v[200:203], a[52:55], v[136:139], v[200:203]
    ds_write_b128 v46, v[188:191] offset:2048
    s_add_u32 s62, s66, 131072
    v_lshl_add_u32 v52, v12, 4, s62
    v_mfma_f32_16x16x32_bf16 v[204:207], a[56:59], v[136:139], v[204:207]
    v_lshrrev_b32 v12, 1, v5
    v_xor_b32 v12, v12, v13
    v_mfma_f32_16x16x32_bf16 v[208:211], a[60:63], v[136:139], v[208:211]
    v_lshlrev_b32 v12, 4, v12
    s_waitcnt vmcnt(10)
    v_mfma_f32_16x16x32_bf16 v[196:199], a[64:67], v[140:143], v[196:199]
    buffer_load_dwordx4 v[72:75], v20, s[48:51], s8 offen offset:1024 sc1
    v_lshl_add_u32 v12, v4, 7, v12
    v_mfma_f32_16x16x32_bf16 v[200:203], a[68:71], v[140:143], v[200:203]
    ds_write_b128 v46, v[192:195] offset:3072
    v_and_b32 v13, 1, v5
    v_lshl_add_u32 v12, v13, 3, v12
    v_mfma_f32_16x16x32_bf16 v[204:207], a[72:75], v[140:143], v[204:207]
    v_add_u32 v48, s62, v12
    v_xor_b32 v49, 32, v48
    v_mfma_f32_16x16x32_bf16 v[208:211], a[76:79], v[140:143], v[208:211]
    v_xor_b32 v50, 64, v48
    s_waitcnt vmcnt(10)
    v_mfma_f32_16x16x32_bf16 v[196:199], a[80:83], v[144:147], v[196:199]
    buffer_load_dwordx4 v[76:79], v20, s[48:51], s8 offen offset:2048 sc1
    v_xor_b32 v51, 96, v48
    v_mfma_f32_16x16x32_bf16 v[200:203], a[84:87], v[144:147], v[200:203]
    s_lshl_b32 s60, s58, 5
    s_sub_u32 s62, 49152, s66
    v_mfma_f32_16x16x32_bf16 v[204:207], a[88:91], v[144:147], v[204:207]
    v_xor_b32 v12, s60, v29
    v_add_u32 v47, s62, v12
    v_mfma_f32_16x16x32_bf16 v[208:211], a[92:95], v[144:147], v[208:211]
    s_add_u32 s21, s20, 8192
    s_waitcnt vmcnt(10)
    v_mfma_f32_16x16x32_bf16 v[196:199], a[96:99], v[148:151], v[196:199]
    buffer_load_dwordx4 v[80:83], v20, s[48:51], s8 offen offset:3072 sc1
    v_mfma_f32_16x16x32_bf16 v[200:203], a[100:103], v[148:151], v[200:203]
    v_cmp_ne_u32 vcc, s64, v67
    s_cbranch_vccnz Lretry9
Lback9:
    v_mfma_f32_16x16x32_bf16 v[204:207], a[104:107], v[148:151], v[204:207]
    v_sub_f32 v67, 1.0, v66
    s_waitcnt lgkmcnt(7)
    v_lshlrev_b32 v212, 16, v58
    v_mfma_f32_16x16x32_bf16 v[208:211], a[108:111], v[148:151], v[208:211]
    v_and_b32 v213, 0xffff0000, v58
    s_waitcnt vmcnt(10)
    v_mfma_f32_16x16x32_bf16 v[196:199], a[112:115], v[152:155], v[196:199]
    buffer_load_dwordx4 v[84:87], v21, s[48:51], s8 offen offset:0 sc1
    v_lshlrev_b32 v214, 16, v59
    v_mfma_f32_16x16x32_bf16 v[200:203], a[116:119], v[152:155], v[200:203]
    v_and_b32 v215, 0xffff0000, v59
    s_waitcnt lgkmcnt(6)
    v_lshlrev_b32 v216, 16, v60
    v_mfma_f32_16x16x32_bf16 v[204:207], a[120:123], v[152:155], v[204:207]
    v_and_b32 v217, 0xffff0000, v60
    v_lshlrev_b32 v218, 16, v61
    v_mfma_f32_16x16x32_bf16 v[208:211], a[124:127], v[152:155], v[208:211]
    v_and_b32 v219, 0xffff0000, v61
    s_waitcnt vmcnt(10)
    v_mfma_f32_16x16x32_bf16 v[196:199], a[128:131], v[156:159], v[196:199]
    buffer_load_dwordx4 v[88:91], v21, s[48:51], s8 offen offset:1024 sc1
    s_waitcnt lgkmcnt(5)
    v_lshlrev_b32 v220, 16, v62
    v_mfma_f32_16x16x32_bf16 v[200:203], a[132:135], v[156:159], v[200:203]
    v_and_b32 v221, 0xffff0000, v62
    v_lshlrev_b32 v222, 16, v63
    v_mfma_f32_16x16x32_bf16 v[204:207], a[136:139], v[156:159], v[204:207]
    v_and_b32 v223, 0xffff0000, v63
    s_waitcnt lgkmcnt(4)
    v_lshlrev_b32 v224, 16, v64
    v_mfma_f32_16x16x32_bf16 v[208:211], a[140:143], v[156:159], v[208:211]
    v_and_b32 v225, 0xffff0000, v64
    s_waitcnt vmcnt(10)
    v_mfma_f32_16x16x32_bf16 v[196:199], a[144:147], v[160:163], v[196:199]
    buffer_load_dwordx4 v[92:95], v21, s[48:51], s8 offen offset:2048 sc1
    v_lshlrev_b32 v226, 16, v65
    v_mfma_f32_16x16x32_bf16 v[200:203], a[148:151], v[160:163], v[200:203]
    v_and_b32 v227, 0xffff0000, v65
    v_mfma_f32_16x16x32_bf16 v[204:207], a[152:155], v[160:163], v[204:207]
    v_mfma_f32_16x16x32_bf16 v[208:211], a[156:159], v[160:163], v[208:211]
    s_waitcnt vmcnt(10)
    v_mfma_f32_16x16x32_bf16 v[196:199], a[160:163], v[164:167], v[196:199]
    buffer_load_dwordx4 v[96:99], v21, s[48:51], s8 offen offset:3072 sc1
    v_mfma_f32_16x16x32_bf16 v[200:203], a[164:167], v[164:167], v[200:203]
    v_mfma_f32_16x16x32_bf16 v[204:207], a[168:171], v[164:167], v[204:207]
    v_mfma_f32_16x16x32_bf16 v[208:211], a[172:175], v[164:167], v[208:211]
    s_waitcnt vmcnt(10)
    v_mfma_f32_16x16x32_bf16 v[196:199], a[176:179], v[168:171], v[196:199]
    buffer_load_dwordx4 v[100:103], v22, s[48:51], s8 offen offset:0 sc1
    v_mfma_f32_16x16x32_bf16 v[200:203], a[180:183], v[168:171], v[200:203]
    v_mfma_f32_16x16x32_bf16 v[204:207], a[184:187], v[168:171], v[204:207]
    v_mfma_f32_16x16x32_bf16 v[208:211], a[188:191], v[168:171], v[208:211]
    s_waitcnt vmcnt(10)
    v_mfma_f32_16x16x32_bf16 v[196:199], a[192:195], v[172:175], v[196:199]
    buffer_load_dwordx4 v[104:107], v22, s[48:51], s8 offen offset:1024 sc1
    v_mfma_f32_16x16x32_bf16 v[200:203], a[196:199], v[172:175], v[200:203]
    v_mfma_f32_16x16x32_bf16 v[204:207], a[200:203], v[172:175], v[204:207]
    v_mfma_f32_16x16x32_bf16 v[208:211], a[204:207], v[172:175], v[208:211]
    s_waitcnt vmcnt(10)
    v_mfma_f32_16x16x32_bf16 v[196:199], a[208:211], v[176:179], v[196:199]
    buffer_load_dwordx4 v[108:111], v22, s[48:51], s8 offen offset:2048 sc1
    v_mfma_f32_16x16x32_bf16 v[200:203], a[212:215], v[176:179], v[200:203]
    v_mfma_f32_16x16x32_bf16 v[204:207], a[216:219], v[176:179], v[204:207]
    v_mfma_f32_16x16x32_bf16 v[208:211], a[220:223], v[176:179], v[208:211]
    s_waitcnt vmcnt(10)
    v_mfma_f32_16x16x32_bf16 v[180:183], a[0:3], v[68:71], 0
    buffer_load_dwordx4 v[112:115], v22, s[48:51], s8 offen offset:3072 sc1
    v_mfma_f32_16x16x32_bf16 v[184:187], a[4:7], v[68:71], 0
    v_mfma_f32_16x16x32_bf16 v[188:191], a[8:11], v[68:71], 0
    v_mfma_f32_16x16x32_bf16 v[192:195], a[12:15], v[68:71], 0
    s_waitcnt vmcnt(10)
    v_mfma_f32_16x16x32_bf16 v[180:183], a[16:19], v[72:75], v[180:183]
    buffer_load_dwordx4 v[116:119], v23, s[48:51], s8 offen offset:0 sc1
    v_mfma_f32_16x16x32_bf16 v[184:187], a[20:23], v[72:75], v[184:187]
    ds_write_b128 v46, v[196:199] offset:16384
    v_mfma_f32_16x16x32_bf16 v[188:191], a[24:27], v[72:75], v[188:191]
    buffer_load_dwordx4 v[68:71], v56, s[48:51], s92 offen sc1
    v_mfma_f32_16x16x32_bf16 v[192:195], a[28:31], v[72:75], v[192:195]
    s_waitcnt vmcnt(11)
    v_mfma_f32_16x16x32_bf16 v[180:183], a[32:35], v[76:79], v[180:183]
    buffer_load_dwordx4 v[120:123], v23, s[48:51], s8 offen offset:1024 sc1
    ds_write_b128 v46, v[200:203] offset:17408
    v_mfma_f32_16x16x32_bf16 v[184:187], a[36:39], v[76:79], v[184:187]
    v_mfma_f32_16x16x32_bf16 v[188:191], a[40:43], v[76:79], v[188:191]
    v_mfma_f32_16x16x32_bf16 v[192:195], a[44:47], v[76:79], v[192:195]
    ds_write_b128 v46, v[204:207] offset:18432
    s_waitcnt vmcnt(11)
    v_mfma_f32_16x16x32_bf16 v[180:183], a[48:51], v[80:83], v[180:183]
    buffer_load_dwordx4 v[124:127], v20, s[48:51], s9 offen offset:0 sc1
    v_mfma_f32_16x16x32_bf16 v[184:187], a[52:55], v[80:83], v[184:187]
    v_mfma_f32_16x16x32_bf16 v[188:191], a[56:59], v[80:83], v[188:191]
    buffer_load_dwordx4 v[72:75], v56, s[48:51], s93 offen sc1
    ds_write_b128 v46, v[208:211] offset:19456
    v_mfma_f32_16x16x32_bf16 v[192:195], a[60:63], v[80:83], v[192:195]
    s_waitcnt vmcnt(12)
    v_mfma_f32_16x16x32_bf16 v[180:183], a[64:67], v[84:87], v[180:183]
    buffer_load_dwordx4 v[128:131], v20, s[48:51], s9 offen offset:1024 sc1
    v_mfma_f32_16x16x32_bf16 v[184:187], a[68:71], v[84:87], v[184:187]
    v_mfma_f32_16x16x32_bf16 v[188:191], a[72:75], v[84:87], v[188:191]
    v_mfma_f32_16x16x32_bf16 v[192:195], a[76:79], v[84:87], v[192:195]
    s_waitcnt vmcnt(12)
    v_mfma_f32_16x16x32_bf16 v[180:183], a[80:83], v[88:91], v[180:183]
    buffer_load_dwordx4 v[132:135], v20, s[48:51], s9 offen offset:2048 sc1
    v_mfma_f32_16x16x32_bf16 v[184:187], a[84:87], v[88:91], v[184:187]
    s_waitcnt lgkmcnt(0)
    s_barrier
    v_mfma_f32_16x16x32_bf16 v[188:191], a[88:91], v[88:91], v[188:191]
    buffer_load_dwordx4 v[76:79], v56, s[48:51], s94 offen sc1
    ds_read_b128 v[228:231], v8 offset:0
    v_mfma_f32_16x16x32_bf16 v[192:195], a[92:95], v[88:91], v[192:195]
    ds_read_b128 v[232:235], v8 offset:1024
    s_waitcnt vmcnt(13)
    v_mfma_f32_16x16x32_bf16 v[180:183], a[96:99], v[92:95], v[180:183]
    buffer_load_dwordx4 v[136:139], v20, s[48:51], s9 offen offset:3072 sc1
    ds_read_b128 v[236:239], v8 offset:2048
    v_mfma_f32_16x16x32_bf16 v[184:187], a[100:103], v[92:95], v[184:187]
    ds_read_b128 v[240:243], v8 offset:3072
    v_mfma_f32_16x16x32_bf16 v[188:191], a[104:107], v[92:95], v[188:191]
    ds_read_b128 v[196:199], v9 offset:0
    v_mfma_f32_16x16x32_bf16 v[192:195], a[108:111], v[92:95], v[192:195]
    ds_read_b128 v[200:203], v9 offset:1024
    s_waitcnt vmcnt(13)
    v_mfma_f32_16x16x32_bf16 v[180:183], a[112:115], v[96:99], v[180:183]
    buffer_load_dwordx4 v[140:143], v21, s[48:51], s9 offen offset:0 sc1
    ds_read_b128 v[204:207], v9 offset:2048
    v_mfma_f32_16x16x32_bf16 v[184:187], a[116:119], v[96:99], v[184:187]
    ds_read_b128 v[208:211], v9 offset:3072
    v_mfma_f32_16x16x32_bf16 v[188:191], a[120:123], v[96:99], v[188:191]
    buffer_load_dwordx4 v[80:83], v56, s[48:51], s95 offen sc1
    v_mfma_f32_16x16x32_bf16 v[192:195], a[124:127], v[96:99], v[192:195]
    s_waitcnt vmcnt(14)
    v_mfma_f32_16x16x32_bf16 v[180:183], a[128:131], v[100:103], v[180:183]
    buffer_load_dwordx4 v[144:147], v21, s[48:51], s9 offen offset:1024 sc1
    v_mfma_f32_16x16x32_bf16 v[184:187], a[132:135], v[100:103], v[184:187]
    v_mfma_f32_16x16x32_bf16 v[188:191], a[136:139], v[100:103], v[188:191]
    s_waitcnt lgkmcnt(7)
    v_add_f32 v212, v212, v228
    v_add_f32 v213, v213, v229
    v_mfma_f32_16x16x32_bf16 v[192:195], a[140:143], v[100:103], v[192:195]
    v_add_f32 v214, v214, v230
    s_waitcnt vmcnt(14)
    v_mfma_f32_16x16x32_bf16 v[180:183], a[144:147], v[104:107], v[180:183]
    buffer_load_dwordx4 v[148:151], v21, s[48:51], s9 offen offset:2048 sc1
    v_add_f32 v215, v215, v231
    v_mfma_f32_16x16x32_bf16 v[184:187], a[148:151], v[104:107], v[184:187]
    s_waitcnt lgkmcnt(6)
    v_add_f32 v216, v216, v232
    v_add_f32 v217, v217, v233
    v_mfma_f32_16x16x32_bf16 v[188:191], a[152:155], v[104:107], v[188:191]
    v_add_f32 v218, v218, v234
    v_add_f32 v219, v219, v235
    v_mfma_f32_16x16x32_bf16 v[192:195], a[156:159], v[104:107], v[192:195]
    s_waitcnt lgkmcnt(5)
    v_add_f32 v220, v220, v236
    s_waitcnt vmcnt(14)
    v_mfma_f32_16x16x32_bf16 v[180:183], a[160:163], v[108:111], v[180:183]
    buffer_load_dwordx4 v[152:155], v21, s[48:51], s9 offen offset:3072 sc1
    v_add_f32 v221, v221, v237
    v_mfma_f32_16x16x32_bf16 v[184:187], a[164:167], v[108:111], v[184:187]
    v_add_f32 v222, v222, v238
    v_add_f32 v223, v223, v239
    v_mfma_f32_16x16x32_bf16 v[188:191], a[168:171], v[108:111], v[188:191]
    s_waitcnt lgkmcnt(4)
    v_add_f32 v224, v224, v240
    v_add_f32 v225, v225, v241
    v_mfma_f32_16x16x32_bf16 v[192:195], a[172:175], v[108:111], v[192:195]
    v_add_f32 v226, v226, v242
    s_waitcnt vmcnt(14)
    v_mfma_f32_16x16x32_bf16 v[180:183], a[176:179], v[112:115], v[180:183]
    buffer_load_dwordx4 v[156:159], v22, s[48:51], s9 offen offset:0 sc1
    v_add_f32 v227, v227, v243
    v_mfma_f32_16x16x32_bf16 v[184:187], a[180:183], v[112:115], v[184:187]
    s_waitcnt lgkmcnt(3)
    v_add_f32 v196, v196, v212
    v_add_f32 v197, v197, v213
    v_mfma_f32_16x16x32_bf16 v[188:191], a[184:187], v[112:115], v[188:191]
    v_add_f32 v198, v198, v214
    v_add_f32 v199, v199, v215
    v_mfma_f32_16x16x32_bf16 v[192:195], a[188:191], v[112:115], v[192:195]
    s_waitcnt lgkmcnt(2)
    v_add_f32 v200, v200, v216
    s_waitcnt vmcnt(14)
    v_mfma_f32_16x16x32_bf16 v[180:183], a[192:195], v[116:119], v[180:183]
    buffer_load_dwordx4 v[160:163], v22, s[48:51], s9 offen offset:1024 sc1
    v_add_f32 v201, v201, v217
    v_mfma_f32_16x16x32_bf16 v[184:187], a[196:199], v[116:119], v[184:187]
    v_add_f32 v202, v202, v218
    v_add_f32 v203, v203, v219
    v_mfma_f32_16x16x32_bf16 v[188:191], a[200:203], v[116:119], v[188:191]
    s_waitcnt lgkmcnt(1)
    v_add_f32 v204, v204, v220
    v_add_f32 v205, v205, v221
    v_mfma_f32_16x16x32_bf16 v[192:195], a[204:207], v[116:119], v[192:195]
    v_add_f32 v206, v206, v222
    s_waitcnt vmcnt(13)
    v_mfma_f32_16x16x32_bf16 v[180:183], a[208:211], v[120:123], v[180:183]
    buffer_load_dwordx4 v[164:167], v22, s[48:51], s9 offen offset:2048 sc1
    v_add_f32 v207, v207, v223
    v_mfma_f32_16x16x32_bf16 v[184:187], a[212:215], v[120:123], v[184:187]
    s_waitcnt lgkmcnt(0)
    v_add_f32 v208, v208, v224
    v_add_f32 v209, v209, v225
    v_mfma_f32_16x16x32_bf16 v[188:191], a[216:219], v[120:123], v[188:191]
    v_add_f32 v210, v210, v226
    v_add_f32 v211, v211, v227
    v_mfma_f32_16x16x32_bf16 v[192:195], a[220:223], v[120:123], v[192:195]
    s_waitcnt vmcnt(13)
    v_mfma_f32_16x16x32_bf16 v[196:199], a[0:3], v[124:127], v[196:199]
    buffer_load_dwordx4 v[168:171], v22, s[48:51], s9 offen offset:3072 sc1
    v_mfma_f32_16x16x32_bf16 v[200:203], a[4:7], v[124:127], v[200:203]
    v_mfma_f32_16x16x32_bf16 v[204:207], a[8:11], v[124:127], v[204:207]
    v_mfma_f32_16x16x32_bf16 v[208:211], a[12:15], v[124:127], v[208:211]
    s_waitcnt vmcnt(12)
    v_mfma_f32_16x16x32_bf16 v[196:199], a[16:19], v[128:131], v[196:199]
    buffer_load_dwordx4 v[172:175], v23, s[48:51], s9 offen offset:0 sc1
    v_mfma_f32_16x16x32_bf16 v[200:203], a[20:23], v[128:131], v[200:203]
    ds_write_b128 v46, v[180:183] offset:32768
    v_mfma_f32_16x16x32_bf16 v[204:207], a[24:27], v[128:131], v[204:207]
    v_mfma_f32_16x16x32_bf16 v[208:211], a[28:31], v[128:131], v[208:211]
    s_waitcnt vmcnt(12)
    v_mfma_f32_16x16x32_bf16 v[196:199], a[32:35], v[132:135], v[196:199]
    buffer_load_dwordx4 v[176:179], v23, s[48:51], s9 offen offset:1024 sc1
    ds_write_b128 v46, v[184:187] offset:33792
    v_mfma_f32_16x16x32_bf16 v[200:203], a[36:39], v[132:135], v[200:203]
    v_mfma_f32_16x16x32_bf16 v[204:207], a[40:43], v[132:135], v[204:207]
    v_mfma_f32_16x16x32_bf16 v[208:211], a[44:47], v[132:135], v[208:211]
    ds_write_b128 v46, v[188:191] offset:34816
    s_waitcnt vmcnt(11)
    v_mfma_f32_16x16x32_bf16 v[196:199], a[48:51], v[136:139], v[196:199]
    v_mfma_f32_16x16x32_bf16 v[200:203], a[52:55], v[136:139], v[200:203]
    v_mfma_f32_16x16x32_bf16 v[204:207], a[56:59], v[136:139], v[204:207]
    ds_write_b128 v46, v[192:195] offset:35840
    v_mfma_f32_16x16x32_bf16 v[208:211], a[60:63], v[136:139], v[208:211]
    s_waitcnt vmcnt(10)
    v_mfma_f32_16x16x32_bf16 v[196:199], a[64:67], v[140:143], v[196:199]
    v_xor_b32 v70, s64, v70
    v_xor_b32 v74, s64, v74
    v_mfma_f32_16x16x32_bf16 v[200:203], a[68:71], v[140:143], v[200:203]
    v_xor_b32 v78, s64, v78
    s_waitcnt vmcnt(9)
    v_xor_b32 v82, s64, v82
    v_mfma_f32_16x16x32_bf16 v[204:207], a[72:75], v[140:143], v[204:207]
    v_or3_b32 v71, v70, v74, v78
    v_or_b32 v71, v71, v82
    v_mfma_f32_16x16x32_bf16 v[208:211], a[76:79], v[140:143], v[208:211]
    s_waitcnt vmcnt(8)
    v_mfma_f32_16x16x32_bf16 v[196:199], a[80:83], v[144:147], v[196:199]
    v_cmp_ne_u32 vcc, 0, v71
    s_cbranch_vccnz Lretry8
Lback8:
    v_mfma_f32_16x16x32_bf16 v[200:203], a[84:87], v[144:147], v[200:203]
    ds_write_b64 v44, v[68:69] offset:0
    v_mfma_f32_16x16x32_bf16 v[204:207], a[88:91], v[144:147], v[204:207]
    ds_write_b64 v45, v[72:73] offset:512
    v_mfma_f32_16x16x32_bf16 v[208:211], a[92:95], v[144:147], v[208:211]
    s_waitcnt vmcnt(7)
    v_mfma_f32_16x16x32_bf16 v[196:199], a[96:99], v[148:151], v[196:199]
    ds_write_b64 v44, v[76:77] offset:1024
    v_mfma_f32_16x16x32_bf16 v[200:203], a[100:103], v[148:151], v[200:203]
    ds_write_b64 v45, v[80:81] offset:1536
    v_mfma_f32_16x16x32_bf16 v[204:207], a[104:107], v[148:151], v[204:207]
    v_mfma_f32_16x16x32_bf16 v[208:211], a[108:111], v[148:151], v[208:211]
    s_waitcnt vmcnt(6)
    v_mfma_f32_16x16x32_bf16 v[196:199], a[112:115], v[152:155], v[196:199]
    s_waitcnt lgkmcnt(0)
    s_barrier
    v_mfma_f32_16x16x32_bf16 v[200:203], a[116:119], v[152:155], v[200:203]
    ds_read_b64_tr_b16 v[244:245], v47 offset:0
    ds_read_b64_tr_b16 v[246:247], v47 offset:4096
    v_mfma_f32_16x16x32_bf16 v[204:207], a[120:123], v[152:155], v[204:207]
    ds_read_b64_tr_b16 v[248:249], v47 offset:8192
    ds_read_b64_tr_b16 v[250:251], v47 offset:12288
    v_mfma_f32_16x16x32_bf16 v[208:211], a[124:127], v[152:155], v[208:211]
    ds_read_b128 v[212:215], v10 offset:0
    ds_read_b128 v[216:219], v10 offset:1024
    s_waitcnt vmcnt(5)
    v_mfma_f32_16x16x32_bf16 v[196:199], a[128:131], v[156:159], v[196:199]
    ds_read_b128 v[220:223], v10 offset:2048
    ds_read_b128 v[224:227], v10 offset:3072
    v_mfma_f32_16x16x32_bf16 v[200:203], a[132:135], v[156:159], v[200:203]
    v_mfma_f32_16x16x32_bf16 v[204:207], a[136:139], v[156:159], v[204:207]
    v_mfma_f32_16x16x32_bf16 v[208:211], a[140:143], v[156:159], v[208:211]
    s_waitcnt vmcnt(4)
    v_mfma_f32_16x16x32_bf16 v[196:199], a[144:147], v[160:163], v[196:199]
    s_waitcnt lgkmcnt(7)
    v_lshlrev_b32 v228, 16, v244
    v_and_b32 v229, 0xffff0000, v244
    v_lshlrev_b32 v230, 16, v245
    v_mfma_f32_16x16x32_bf16 v[200:203], a[148:151], v[160:163], v[200:203]
    v_and_b32 v231, 0xffff0000, v245
    s_waitcnt lgkmcnt(6)
    v_lshlrev_b32 v232, 16, v246
    v_and_b32 v233, 0xffff0000, v246
    v_mfma_f32_16x16x32_bf16 v[204:207], a[152:155], v[160:163], v[204:207]
    v_lshlrev_b32 v234, 16, v247
    v_and_b32 v235, 0xffff0000, v247
    s_waitcnt lgkmcnt(5)
    v_lshlrev_b32 v236, 16, v248
    v_mfma_f32_16x16x32_bf16 v[208:211], a[156:159], v[160:163], v[208:211]
    v_and_b32 v237, 0xffff0000, v248
    v_lshlrev_b32 v238, 16, v249
    s_waitcnt vmcnt(3)
    v_mfma_f32_16x16x32_bf16 v[196:199], a[160:163], v[164:167], v[196:199]
    v_and_b32 v239, 0xffff0000, v249
Lpg4:
    s_cbranch_execz Liw_ret
    s_waitcnt lgkmcnt(4)
    v_lshlrev_b32 v240, 16, v250
    v_and_b32 v241, 0xffff0000, v250
    v_mfma_f32_16x16x32_bf16 v[200:203], a[164:167], v[164:167], v[200:203]
    v_lshlrev_b32 v242, 16, v251
    v_and_b32 v243, 0xffff0000, v251
    v_mul_f32 v228, v66, v228
    v_mfma_f32_16x16x32_bf16 v[204:207], a[168:171], v[164:167], v[204:207]
    v_mul_f32 v229, v66, v229
    v_mul_f32 v230, v66, v230
    v_mul_f32 v231, v66, v231
    v_mfma_f32_16x16x32_bf16 v[208:211], a[172:175], v[164:167], v[208:211]
    v_mul_f32 v232, v66, v232
    v_mul_f32 v233, v66, v233
    s_waitcnt vmcnt(2)
    v_mfma_f32_16x16x32_bf16 v[196:199], a[176:179], v[168:171], v[196:199]
    v_mul_f32 v234, v66, v234
    v_mul_f32 v235, v66, v235
    v_mul_f32 v236, v66, v236
    v_mfma_f32_16x16x32_bf16 v[200:203], a[180:183], v[168:171], v[200:203]
    v_mul_f32 v237, v66, v237
    v_mul_f32 v238, v66, v238
    v_mul_f32 v239, v66, v239
    v_mfma_f32_16x16x32_bf16 v[204:207], a[184:187], v[168:171], v[204:207]
    v_mul_f32 v240, v66, v240
    v_mul_f32 v241, v66, v241
    v_mul_f32 v242, v66, v242
    v_mfma_f32_16x16x32_bf16 v[208:211], a[188:191], v[168:171], v[208:211]
    v_mul_f32 v243, v66, v243
    s_waitcnt lgkmcnt(3)
    v_fma_f32 v212, v212, v67, v228
    s_waitcnt vmcnt(1)
    v_mfma_f32_16x16x32_bf16 v[196:199], a[192:195], v[172:175], v[196:199]
    v_fma_f32 v213, v213, v67, v229
    v_fma_f32 v214, v214, v67, v230
    v_fma_f32 v215, v215, v67, v231
    v_mfma_f32_16x16x32_bf16 v[200:203], a[196:199], v[172:175], v[200:203]
    s_waitcnt lgkmcnt(2)
    v_fma_f32 v216, v216, v67, v232
    v_fma_f32 v217, v217, v67, v233
    v_fma_f32 v218, v218, v67, v234
    v_mfma_f32_16x16x32_bf16 v[204:207], a[200:203], v[172:175], v[204:207]
    v_fma_f32 v219, v219, v67, v235
    s_waitcnt lgkmcnt(1)
    v_fma_f32 v220, v220, v67, v236
    v_fma_f32 v221, v221, v67, v237
    v_mfma_f32_16x16x32_bf16 v[208:211], a[204:207], v[172:175], v[208:211]
    v_fma_f32 v222, v222, v67, v238
    v_fma_f32 v223, v223, v67, v239
    s_waitcnt vmcnt(0)
    v_mfma_f32_16x16x32_bf16 v[196:199], a[208:211], v[176:179], v[196:199]
    s_waitcnt lgkmcnt(0)
    v_fma_f32 v224, v224, v67, v240
    v_fma_f32 v225, v225, v67, v241
    v_fma_f32 v226, v226, v67, v242
    v_mfma_f32_16x16x32_bf16 v[200:203], a[212:215], v[176:179], v[200:203]
    v_fma_f32 v227, v227, v67, v243
    v_mfma_f32_16x16x32_bf16 v[204:207], a[216:219], v[176:179], v[204:207]
    v_mfma_f32_16x16x32_bf16 v[208:211], a[220:223], v[176:179], v[208:211]
    v_pk_fma_f32 v[212:213], v[196:197], v[66:67], v[212:213] op_sel:[0,1,0] op_sel_hi:[1,1,1]
    v_pk_fma_f32 v[214:215], v[198:199], v[66:67], v[214:215] op_sel:[0,1,0] op_sel_hi:[1,1,1]
    s_nop 2
    v_pk_fma_f32 v[216:217], v[200:201], v[66:67], v[216:217] op_sel:[0,1,0] op_sel_hi:[1,1,1]
    v_pk_fma_f32 v[218:219], v[202:203], v[66:67], v[218:219] op_sel:[0,1,0] op_sel_hi:[1,1,1]
    v_pk_fma_f32 v[220:221], v[204:205], v[66:67], v[220:221] op_sel:[0,1,0] op_sel_hi:[1,1,1]
    v_pk_fma_f32 v[222:223], v[206:207], v[66:67], v[222:223] op_sel:[0,1,0] op_sel_hi:[1,1,1]
    v_pk_fma_f32 v[224:225], v[208:209], v[66:67], v[224:225] op_sel:[0,1,0] op_sel_hi:[1,1,1]
    v_pk_fma_f32 v[226:227], v[210:211], v[66:67], v[226:227] op_sel:[0,1,0] op_sel_hi:[1,1,1]
    v_cvt_pk_bf16_f32 v244, v212, v213
    v_cvt_pk_bf16_f32 v245, v214, v215
    v_cvt_pk_bf16_f32 v246, v216, v217
    v_cvt_pk_bf16_f32 v247, v218, v219
    v_cvt_pk_bf16_f32 v248, v220, v221
    v_cvt_pk_bf16_f32 v249, v222, v223
    v_cvt_pk_bf16_f32 v250, v224, v225
    v_cvt_pk_bf16_f32 v251, v226, v227
    ds_write_b64 v48, v[244:245]
    ds_write_b64 v49, v[246:247]
    ds_write_b64 v50, v[248:249]
    ds_write_b64 v51, v[250:251]
    ds_read_b128 v[228:231], v52 offset:0
    ds_read_b128 v[232:235], v52 offset:1024
    s_waitcnt lgkmcnt(1)
    buffer_store_dwordx4 v[228:231], v53, s[52:55], s20 offen sc1
    s_waitcnt lgkmcnt(0)
    buffer_store_dwordx4 v[232:235], v53, s[52:55], s21 offen sc1
Lend:
    s_endpgm
Lretry0:
    s_mov_b32 s79, 0x40000
Lloop0:
    s_sleep 2
    s_mov_b32 s70, m0
    s_add_u32 m0, s78, 4352
    s_nop 0
    buffer_load_dwordx4 v20, s[48:51], s60 offen offset:0 sc1 lds
    buffer_load_dwordx4 v20, s[48:51], s61 offen offset:1024 sc1 lds
    buffer_load_dwordx4 v20, s[48:51], s83 offen offset:2048 sc1 lds
    s_waitcnt vmcnt(0)
    ds_read_b128 v[146:149], v8 offset:4352
    ds_read_b128 v[150:153], v8 offset:4608
    ds_read_b128 v[154:157], v8 offset:4864
    ds_read_b128 v[158:161], v8 offset:5120
    ds_read_b128 v[162:165], v8 offset:5376
    ds_read_b128 v[166:169], v8 offset:5632
    ds_read_b128 v[170:173], v8 offset:5888
    ds_read_b128 v[174:177], v8 offset:6144
    ds_read_b128 v[230:233], v8 offset:6400
    ds_read_b128 v[234:237], v8 offset:6656
    ds_read_b128 v[238:241], v8 offset:6912
    ds_read_b128 v[242:245], v8 offset:7168
    s_mov_b32 m0, s70
    s_waitcnt lgkmcnt(0)
    v_xor_b32 v149, s64, v149
    v_xor_b32 v153, s64, v153
    v_xor_b32 v157, s64, v157
    v_xor_b32 v161, s64, v161
    v_xor_b32 v165, s64, v165
    v_xor_b32 v169, s64, v169
    v_xor_b32 v173, s64, v173
    v_xor_b32 v177, s64, v177
    v_xor_b32 v233, s64, v233
    v_xor_b32 v237, s64, v237
    v_xor_b32 v241, s64, v241
    v_xor_b32 v245, s64, v245
    v_or3_b32 v9, v149, v153, v157
    v_or3_b32 v9, v9, v161, v165
    v_or3_b32 v9, v9, v169, v173
    v_or3_b32 v9, v9, v177, v233
    v_or3_b32 v9, v9, v237, v241
    v_or3_b32 v9, v9, v245, v245
    v_cmp_ne_u32 vcc, 0, v9
    s_cbranch_vccz Lback0
    s_sub_u32 s79, s79, 1
    s_cbranch_scc0 Lloop0
    s_branch Lback0
Lretry1:
    s_mov_b32 s79, 0x40000
Lloop1:
    s_sleep 2
    global_load_dword v6, v2, s[32:33] sc1
    s_waitcnt vmcnt(0)
    v_readfirstlane_b32 s64, v6
    s_nop 3
    s_cmp_eq_u32 s64, 0
    s_cbranch_scc0 Lback1
    s_sub_u32 s79, s79, 1
    s_cbranch_scc0 Lloop1
    s_branch Lback1
Lretry3:
    s_mov_b32 s79, 0x40000
Lloop3:
    s_sleep 2
    buffer_load_dword v7, v24, s[48:51], s13 offen sc1
    s_waitcnt vmcnt(0)
    v_cmp_ne_u32 vcc, s64, v7
    s_cbranch_vccz Lback3
    s_sub_u32 s79, s79, 1
    s_cbranch_scc0 Lloop3
    s_branch Lback3
Lretry4:
    s_mov_b32 s79, 0x40000
Lloop4:
    s_sleep 2
    global_load_dword v6, v2, s[32:33] sc1
    s_waitcnt vmcnt(0)
    v_readfirstlane_b32 s64, v6
    s_nop 3
    s_cmp_eq_u32 s64, 0
    s_cbranch_scc0 Lback4
    s_sub_u32 s79, s79, 1
    s_cbranch_scc0 Lloop4
    s_branch Lback4
Lretry6:
    s_mov_b32 s79, 0x40000
Lloop6:
    s_sleep 2
    buffer_load_dword v7, v24, s[48:51], s13 offen sc1
    s_waitcnt vmcnt(0)
    v_cmp_ne_u32 vcc, s64, v7
    s_cbranch_vccz Lback6
    s_sub_u32 s79, s79, 1
    s_cbranch_scc0 Lloop6
    s_branch Lback6
Lretry7:
    s_mov_b32 s79, 0x40000
Lloop7:
    s_sleep 2
    buffer_load_dword v7, v24, s[48:51], s15 offen sc1
    s_waitcnt vmcnt(0)
    v_cmp_ne_u32 vcc, s64, v7
    s_cbranch_vccz Lback7
    s_sub_u32 s79, s79, 1
    s_cbranch_scc0 Lloop7
    s_branch Lback7
Lretry8:
    s_mov_b32 s79, 0x40000
Lloop8:
    s_sleep 2
    buffer_load_dwordx4 v[68:71], v56, s[48:51], s92 offen sc1
    buffer_load_dwordx4 v[72:75], v56, s[48:51], s93 offen sc1
    buffer_load_dwordx4 v[76:79], v56, s[48:51], s94 offen sc1
    buffer_load_dwordx4 v[80:83], v56, s[48:51], s95 offen sc1
    s_waitcnt vmcnt(0)
    v_xor_b32 v70, s64, v70
    v_xor_b32 v74, s64, v74
    v_xor_b32 v78, s64, v78
    v_xor_b32 v82, s64, v82
    v_or3_b32 v71, v70, v74, v78
    v_or_b32 v71, v71, v82
    v_cmp_ne_u32 vcc, 0, v71
    s_cbranch_vccz Lback8
    s_sub_u32 s79, s79, 1
    s_cbranch_scc0 Lloop8
    s_branch Lback8
Lretry9:
    s_mov_b32 s79, 0x40000
Lloop9:
    s_sleep 2
    buffer_load_dwordx2 v[66:67], v55, s[48:51], s17 offen sc1
    s_waitcnt vmcnt(0)
    v_cmp_ne_u32 vcc, s64, v67
    s_cbranch_vccz Lback9
    s_sub_u32 s79, s79, 1
    s_cbranch_scc0 Lloop9
    s_branch Lback9
.p2align 12
Lspare:
    v_lshrrev_b32 v8, 6, v0
    v_and_b32 v1, 63, v0
    v_readfirstlane_b32 s58, v8
    v_mov_b32 v2, 0
    s_and_b32 s56, s2, 7
    s_lshr_b32 s57, s2, 3
    s_lshl2_add_u32 s60, s57, s58
    s_mul_i32 s60, s60, 384
    v_and_b32 v9, 3, v1
    v_lshl_add_u32 v9, v9, 7, s60
    v_min_u32 v9, Lcode_end-Lpc-4, v9
    global_load_dword v7, v9, s[62:63]
    s_lshl_b32 s60, s2, 9
    v_lshl_add_u32 v47, v0, 1, s60
    s_lshl_b32 s79, s2, 2
    v_lshlrev_b32 v20, 4, v1
    v_and_b32 v4, 15, v1
    v_lshrrev_b32 v5, 4, v1
    s_mov_b32 s38, 0x200000
    s_mov_b32 s39, 0x20000
    s_mov_b32 s42, 1835008
    s_mov_b32 s43, 0x20000
    s_lshl_b32 s66, s58, 12
    s_lshl_b32 s78, s58, 13
    s_lshl_b32 s91, s58, 11
    s_and_b32 s59, s58, 1
    s_lshr_b32 s60, s56, 1
    s_and_b32 s61, s57, 7
    s_lshl3_add_u32 s98, s60, s61
    s_and_b32 s60, s56, 1
    s_lshr_b32 s61, s57, 3
    s_lshl2_add_u32 s99, s60, s61
    s_lshl2_add_u32 s3, s98, s58
    s_lshl_b32 s3, s3, 7
    s_add_u32 s3, s3, s99
    s_lshl_b32 s3, s3, 7
    s_lshl_b32 s60, s58, 1
    v_and_b32 v10, 7, v1
    v_xor_b32 v10, s60, v10
    v_lshrrev_b32 v11, 3, v1
    v_lshlrev_b32 v11, 10, v11
    v_lshl_add_u32 v37, v10, 4, v11
    v_xor_b32 v38, 16, v37
    v_add_u32 v38, 7168, v38
    s_sub_u32 s83, s57, 28
    s_lshl2_add_u32 s75, s56, s83
    s_lshl2_add_u32 s67, s75, s58
    s_lshl_b32 s67, s67, 14
    s_lshl_b32 s61, s58, 2
    v_and_b32 v8, 31, v1
    v_xor_b32 v8, s61, v8
    v_lshrrev_b32 v9, 5, v1
    v_lshlrev_b32 v9, 10, v9
    v_lshl_add_u32 v49, v8, 4, v9
    v_xor_b32 v50, 32, v49
    s_waitcnt lgkmcnt(0)
    s_load_dword s96, s[14:15], s79
    s_load_dword s97, s[16:17], s79
    s_add_u32 m0, s91, 24576
    s_nop 0
    buffer_load_dwordx4 v37, s[36:39], s3 offen offset:0 lds
    buffer_load_dwordx4 v38, s[36:39], s3 offen offset:1024 lds
    global_load_ushort v41, v47, s[6:7]
    global_load_ushort v42, v47, s[8:9]
    global_load_ushort v43, v47, s[10:11]
    global_load_ushort v44, v47, s[12:13]
    s_add_u32 m0, s78, 32768
    s_add_u32 s70, s67, 0
    buffer_load_dwordx4 v49, s[36:39], s70 offen offset:0 lds
    s_add_u32 s70, s67, 1024
    buffer_load_dwordx4 v49, s[36:39], s70 offen offset:1024 lds
    s_add_u32 s70, s67, 2048
    buffer_load_dwordx4 v49, s[36:39], s70 offen offset:2048 lds
    s_lshr_b32 s61, s56, 1
    s_lshl2_add_u32 s60, s61, s83
    s_min_u32 s60, s60, 13
    s_and_b32 s61, s56, 1
    s_mul_i32 s61, s61, 14
    s_add_u32 s76, s60, s61
    s_lshl_b32 s62, s76, 7
    s_lshl_b32 s60, s58, 5
    s_add_u32 s60, s60, s62
    v_lshl_add_u32 v55, v4, 1, s60
    v_lshlrev_b32 v8, 1, v5
    v_and_b32 v9, 7, v1
    v_xor_b32 v8, v8, v9
    v_lshrrev_b32 v9, 3, v1
    s_add_u32 s70, s67, 3072
    buffer_load_dwordx4 v49, s[36:39], s70 offen offset:3072 lds
    v_mul_u32_u24 v9, 3584, v9
    v_lshl_add_u32 v51, v8, 4, v9
    v_add_u32 v52, 27648, v51
    v_add_u32 v53, 55296, v51
    v_add_u32 v54, 82944, v51
    s_mul_i32 s68, s58, 458752
    s_add_u32 s68, s68, s62
    s_sub_u32 s68, s68, 114688
    s_lshl2_add_u32 s74, s75, s58
    s_lshl_b32 s74, s74, 7
    s_add_u32 s74, s74, 36864
    s_mov_b32 s80, s75
    s_mov_b32 s81, 3
    v_and_b32 v8, 7, v4
    s_add_u32 m0, s78, 36864
    s_add_u32 s70, s67, 8192
    buffer_load_dwordx4 v50, s[36:39], s70 offen offset:0 lds
    v_lshrrev_b32 v9, 3, v4
    v_lshl_add_u32 v9, v8, 3, v9
    s_lshl_b32 s60, s58, 1
    v_add_u32 v15, s60, v9
    v_lshlrev_b32 v8, 1, v8
    v_xor_b32 v8, v8, v5
    v_lshlrev_b32 v9, 9, v15
    v_add_u32 v9, 32768, v9
    v_lshlrev_b32 v80, 4, v5
    v_add_u32 v80, 16384, v80
    v_xor_b32 v76, 0, v8
    v_lshl_add_u32 v76, v76, 4, v9
    v_mov_b32 v158, 0x3f803f80
    v_xor_b32 v77, 4, v8
    s_add_u32 s70, s67, 9216
    buffer_load_dwordx4 v50, s[36:39], s70 offen offset:1024 lds
    v_lshl_add_u32 v77, v77, 4, v9
    v_mov_b32 v159, 0x3f803f80
    v_xor_b32 v78, 8, v8
    v_lshl_add_u32 v78, v78, 4, v9
    v_mov_b32 v160, 0x3f803f80
    v_xor_b32 v79, 12, v8
    v_lshl_add_u32 v79, v79, 4, v9
    v_mov_b32 v161, 0x3f803f80
    v_lshrrev_b32 v8, 2, v1
    v_bfe_u32 v9, v1, 3, 2
    v_xor_b32 v9, s58, v9
    v_lshlrev_b32 v8, 7, v8
    v_lshl_add_u32 v8, v9, 5, v8
    v_and_b32 v9, 3, v1
    v_lshl_add_u32 v8, v9, 3, v8
    s_add_u32 s70, s67, 10240
    buffer_load_dwordx4 v50, s[36:39], s70 offen offset:2048 lds
    v_add_u32 v81, 98304, v8
    v_lshrrev_b32 v8, 2, v4
    v_cmp_eq_u32 vcc, v8, v5
    v_lshlrev_b32 v8, 4, v15
    v_mov_b32 v12, 0x7ff00000
    v_cndmask_b32 v85, v12, v8, vcc
    s_lshl_b32 s60, s75, 10
    s_add_u32 s73, s60, 557056
    s_add_u32 s72, s60, 524288
    s_mov_b64 s[44:45], s[24:25]
    s_mov_b32 s46, 1835008
    s_mov_b32 s47, 0x20000
    s_mov_b64 s[48:49], s[34:35]
    s_mov_b32 s50, 268435456
    s_add_u32 s70, s67, 11264
    buffer_load_dwordx4 v50, s[36:39], s70 offen offset:3072 lds
    s_mov_b32 s51, 0x20000
    s_mov_b64 s[52:53], s[30:31]
    s_mov_b32 s54, 2097152
    s_mov_b32 s55, 0x20000
    v_and_b32 v8, 7, v1
    v_lshrrev_b32 v9, 5, v1
    v_lshl_add_u32 v9, s58, 1, v9
    v_xor_b32 v9, v9, v8
    v_lshlrev_b32 v9, 4, v9
    v_lshl_add_u32 v9, v8, 10, v9
    v_bfe_u32 v10, v1, 3, 2
    v_lshl_add_u32 v9, v10, 2, v9
    v_add_u32 v39, 24576, v9
    v_lshrrev_b32 v9, 3, v1
    s_add_u32 m0, s78, 65536
    s_add_u32 s70, s67, 512
    buffer_load_dwordx4 v49, s[36:39], s70 offen offset:0 lds
    v_lshlrev_b32 v9, 13, v9
    v_lshl_add_u32 v40, v8, 4, v9
    s_lshl2_add_u32 s60, s99, s58
    s_lshl_b32 s60, s60, 9
    s_lshl_b32 s99, s99, 5
    s_add_u32 s99, s99, s98
    s_lshl_b32 s99, s99, 4
    s_add_u32 s99, s99, 65536
    s_add_u32 s98, s98, s60
    s_lshl_b32 s98, s98, 7
    s_add_u32 s98, s98, 2097152
    s_add_u32 s3, s98, 4096
    s_mov_b32 s18, 0x05040100
    s_mov_b32 s19, 0x07060302
    v_mul_u32_u24 v8, 272, v4
    v_lshl_add_u32 v8, v5, 4, v8
    v_add_u32 v72, s78, v8
    s_add_u32 s61, s78, 4352
    v_mov_b32 v75, s61
    v_lshlrev_b32 v73, 4, v0
    v_bfe_u32 v8, v1, 2, 2
    v_bfe_u32 v9, v1, 2, 1
    v_lshlrev_b32 v8, 13, v8
    v_lshl_add_u32 v8, v9, 7, v8
    v_and_b32 v9, 3, v1
    v_lshl_add_u32 v74, v9, 4, v8
    v_mov_b32 v16, 0
    v_mov_b32 v17, 0
    v_mov_b32 v18, 0
    v_mov_b32 v19, 0
    v_lshrrev_b32 v8, 1, v5
    v_and_b32 v9, 1, v5
    v_mul_u32_u24 v9, 400, v9
    v_lshl_add_u32 v9, v8, 4, v9
    v_add_u32 v9, v9, v4
    v_lshl_add_u32 v67, v9, 2, s61
    v_add_u32 v68, 800, v67
    v_sub_u32 v9, 2, v8
    v_lshlrev_b32 v9, v9, v4
    v_lshrrev_b32 v10, 3, v9
    v_and_b32 v9, 7, v9
    v_mul_u32_u24 v9, 100, v9
    v_lshl_add_u32 v10, v5, 3, v10
    v_add3_u32 v9, v9, v10, 32
    v_lshl_add_u32 v69, v9, 2, s61
    v_mul_u32_u24 v8, 784, v8
    v_sub_u32 v8, 800, v8
    v_add_u32 v70, v69, v8
    v_and_b32 v8, 7, v4
    v_mul_u32_u24 v8, 100, v8
    v_lshrrev_b32 v9, 3, v4
    v_lshl_add_u32 v9, v5, 3, v9
    v_add3_u32 v8, v8, v9, 64
    v_lshl_add_u32 v71, v8, 2, s61
    s_waitcnt vmcnt(13)
    s_barrier
    ds_read2_b32 v[126:127], v39 offset0:0 offset1:32
    ds_read2_b32 v[128:129], v39 offset0:64 offset1:96
    ds_read2_b32 v[130:131], v39 offset0:128 offset1:160
    ds_read2_b32 v[132:133], v39 offset0:192 offset1:224
    s_add_u32 s70, s67, 1536
    buffer_load_dwordx4 v49, s[36:39], s70 offen offset:1024 lds
    s_lshr_b32 s60, s58, 1
    s_lshl_b32 s60, s60, 4
    s_waitcnt lgkmcnt(0)
    s_lshr_b32 s96, s96, s60
    s_lshr_b32 s97, s97, s60
    v_lshlrev_b32 v45, 16, s96
    v_lshlrev_b32 v46, 16, s97
    s_mov_b32 s60, 0x3fb8aa3b
    s_waitcnt vmcnt(13)
    v_lshlrev_b32 v41, 16, v41
    v_mul_f32 v8, s60, v41
    v_mul_f32 v10, s60, v45
    v_fma_f32 v9, v41, s60, -v8
    s_add_u32 s70, s67, 2560
    buffer_load_dwordx4 v49, s[36:39], s70 offen offset:2048 lds
    v_fma_f32 v11, v45, s60, -v10
    v_exp_f32 v8, v8
    v_exp_f32 v10, v10
    v_fmamk_f32 v9, v41, 0x32a5705f, v9
    v_fmamk_f32 v11, v45, 0x32a5705f, v11
    v_mul_f32 v9, 0x3f317218, v9
    v_mul_f32 v11, 0x3f317218, v11
    v_fma_f32 v8, v8, v9, v8
    v_fma_f32 v10, v10, v11, v10
    s_waitcnt vmcnt(13)
    v_lshlrev_b32 v42, 16, v42
    s_waitcnt vmcnt(12)
    v_lshlrev_b32 v43, 16, v43
    s_waitcnt vmcnt(11)
    v_lshlrev_b32 v44, 16, v44
    s_add_u32 s70, s67, 3584
    buffer_load_dwordx4 v49, s[36:39], s70 offen offset:3072 lds
    v_cvt_pk_bf16_f32 v8, v8, v10
    v_and_b32 v45, 0xffff0000, v8
    v_lshlrev_b32 v41, 16, v8
    v_mul_f32 v41, v41, v45
    v_mul_f32 v42, v42, v45
    v_add_f32 v45, v45, v45
    v_mul_f32 v41, 0xbfb8aa3b, v41
    v_mul_f32 v42, 0.15915494, v42
    v_mul_f32 v162, v43, v45
    v_mul_f32 v163, v44, v45
    v_mul_f32 v8, 0x41000000, v41
    v_mul_f32 v9, 0x41000000, v42
    s_add_u32 m0, s78, 69632
    s_add_u32 s70, s67, 8704
    buffer_load_dwordx4 v50, s[36:39], s70 offen offset:0 lds
    v_mul_f32 v10, 0x3f800000, v41
    v_mul_f32 v11, 0x3f800000, v42
    v_mul_f32 v12, 0x43000000, v41
    v_mul_f32 v13, 0x43000000, v42
    v_fract_f32 v9, v9
    v_exp_f32 v8, v8
    v_fract_f32 v11, v11
    v_exp_f32 v10, v10
    v_fract_f32 v13, v13
    v_exp_f32 v12, v12
    v_cos_f32 v94, v9
    v_sin_f32 v95, v9
    s_add_u32 s70, s67, 9728
    buffer_load_dwordx4 v50, s[36:39], s70 offen offset:1024 lds
    v_cos_f32 v96, v11
    v_sin_f32 v97, v11
    v_cos_f32 v164, v13
    v_sin_f32 v165, v13
    v_pk_mul_f32 v[94:95], v[94:95], v[8:9] op_sel_hi:[1,0]
    v_pk_mul_f32 v[96:97], v[96:97], v[10:11] op_sel_hi:[1,0]
    v_pk_mul_f32 v[164:165], v[164:165], v[12:13] op_sel_hi:[1,0]
    s_lshl_b32 s60, s59, 6
    s_sub_u32 s60, 64, s60
    v_cmp_eq_u32 vcc, s60, v1
    v_accvgpr_write_b32 a225, 0
    v_accvgpr_write_b32 a226, 0
    s_add_u32 s70, s67, 10752
    buffer_load_dwordx4 v50, s[36:39], s70 offen offset:2048 lds
    v_cndmask_b32 v46, 0, v46, vcc
    v_accvgpr_write_b32 a227, 0
    v_accvgpr_write_b32 a224, v46
    v_mov_b32 v198, 0x3f80
    v_cvt_pk_bf16_f32 v199, v94, -v95
    v_cvt_pk_bf16_f32 v200, v162, v163
    v_pk_mul_f32 v[98:99], v[94:95], v[94:95] op_sel_hi:[1,0]
    v_pk_mul_f32 v[166:167], v[164:165], v[164:165] op_sel_hi:[1,0]
    v_pk_mul_f32 v[168:169], v[162:163], v[96:97] op_sel_hi:[1,0]
    v_pk_fma_f32 v[98:99], v[94:95], v[94:95], v[98:99] op_sel:[1,1,0] op_sel_hi:[0,1,1] neg_lo:[1,0,0]
    v_pk_fma_f32 v[166:167], v[164:165], v[164:165], v[166:167] op_sel:[1,1,0] op_sel_hi:[0,1,1] neg_lo:[1,0,0]
    v_pk_fma_f32 v[168:169], v[162:163], v[96:97], v[168:169] op_sel:[1,1,0] op_sel_hi:[0,1,1] neg_lo:[1,0,0]
    s_add_u32 s70, s67, 11776
    buffer_load_dwordx4 v50, s[36:39], s70 offen offset:3072 lds
    v_cvt_pk_bf16_f32 v201, v98, -v99
    v_cvt_pk_bf16_f32 v202, v168, v169
    v_pk_mul_f32 v[100:101], v[98:99], v[94:95] op_sel_hi:[1,0]
    v_pk_mul_f32 v[102:103], v[98:99], v[98:99] op_sel_hi:[1,0]
    v_pk_mul_f32 v[170:171], v[168:169], v[96:97] op_sel_hi:[1,0]
    v_pk_fma_f32 v[100:101], v[98:99], v[94:95], v[100:101] op_sel:[1,1,0] op_sel_hi:[0,1,1] neg_lo:[1,0,0]
    v_pk_fma_f32 v[102:103], v[98:99], v[98:99], v[102:103] op_sel:[1,1,0] op_sel_hi:[0,1,1] neg_lo:[1,0,0]
    v_pk_fma_f32 v[170:171], v[168:169], v[96:97], v[170:171] op_sel:[1,1,0] op_sel_hi:[0,1,1] neg_lo:[1,0,0]
    v_cvt_pk_bf16_f32 v203, v100, -v101
    v_cvt_pk_bf16_f32 v204, v102, -v103
    v_cvt_pk_bf16_f32 v205, v170, v171
    v_pk_mul_f32 v[104:105], v[94:95], v[102:103] op_sel_hi:[1,0]
    global_load_dword v6, v2, s[32:33] sc1
    v_pk_mul_f32 v[106:107], v[98:99], v[102:103] op_sel_hi:[1,0]
    v_pk_mul_f32 v[172:173], v[170:171], v[96:97] op_sel_hi:[1,0]
    v_pk_fma_f32 v[104:105], v[94:95], v[102:103], v[104:105] op_sel:[1,1,0] op_sel_hi:[0,1,1] neg_lo:[1,0,0]
    v_pk_fma_f32 v[106:107], v[98:99], v[102:103], v[106:107] op_sel:[1,1,0] op_sel_hi:[0,1,1] neg_lo:[1,0,0]
    v_pk_fma_f32 v[172:173], v[170:171], v[96:97], v[172:173] op_sel:[1,1,0] op_sel_hi:[0,1,1] neg_lo:[1,0,0]
    v_cvt_pk_bf16_f32 v206, v104, -v105
    v_cvt_pk_bf16_f32 v207, v106, -v107
    v_cvt_pk_bf16_f32 v208, v172, v173
    v_pk_mul_f32 v[94:95], v[100:101], v[102:103] op_sel_hi:[1,0]
    v_pk_mul_f32 v[98:99], v[102:103], v[102:103] op_sel_hi:[1,0]
    v_pk_mul_f32 v[174:175], v[172:173], v[96:97] op_sel_hi:[1,0]
    v_pk_fma_f32 v[94:95], v[100:101], v[102:103], v[94:95] op_sel:[1,1,0] op_sel_hi:[0,1,1] neg_lo:[1,0,0]
    s_add_u32 s68, s68, 114688
    v_pk_fma_f32 v[98:99], v[102:103], v[102:103], v[98:99] op_sel:[1,1,0] op_sel_hi:[0,1,1] neg_lo:[1,0,0]
    v_pk_fma_f32 v[174:175], v[172:173], v[96:97], v[174:175] op_sel:[1,1,0] op_sel_hi:[0,1,1] neg_lo:[1,0,0]
    v_cvt_pk_bf16_f32 v209, v94, -v95
    v_cvt_pk_bf16_f32 v210, v98, -v99
    v_cvt_pk_bf16_f32 v211, v174, v175
    v_pk_mul_f32 v[100:101], v[104:105], v[102:103] op_sel_hi:[1,0]
    v_pk_mul_f32 v[108:109], v[106:107], v[102:103] op_sel_hi:[1,0]
    v_pk_mul_f32 v[176:177], v[174:175], v[96:97] op_sel_hi:[1,0]
    v_pk_fma_f32 v[100:101], v[104:105], v[102:103], v[100:101] op_sel:[1,1,0] op_sel_hi:[0,1,1] neg_lo:[1,0,0]
    v_pk_fma_f32 v[108:109], v[106:107], v[102:103], v[108:109] op_sel:[1,1,0] op_sel_hi:[0,1,1] neg_lo:[1,0,0]
    v_pk_fma_f32 v[176:177], v[174:175], v[96:97], v[176:177] op_sel:[1,1,0] op_sel_hi:[0,1,1] neg_lo:[1,0,0]
    s_lshl2_add_u32 m0, s66, 98304
    v_cvt_pk_bf16_f32 v212, v100, -v101
    buffer_load_dwordx4 v51, s[40:43], s68 offen offset:0 lds
    v_cvt_pk_bf16_f32 v213, v108, -v109
    v_cvt_pk_bf16_f32 v214, v176, v177
    v_pk_mul_f32 v[104:105], v[94:95], v[102:103] op_sel_hi:[1,0]
    v_pk_mul_f32 v[106:107], v[98:99], v[102:103] op_sel_hi:[1,0]
    v_pk_mul_f32 v[178:179], v[176:177], v[96:97] op_sel_hi:[1,0]
    v_pk_fma_f32 v[104:105], v[94:95], v[102:103], v[104:105] op_sel:[1,1,0] op_sel_hi:[0,1,1] neg_lo:[1,0,0]
    v_pk_fma_f32 v[106:107], v[98:99], v[102:103], v[106:107] op_sel:[1,1,0] op_sel_hi:[0,1,1] neg_lo:[1,0,0]
    v_pk_fma_f32 v[178:179], v[176:177], v[96:97], v[178:179] op_sel:[1,1,0] op_sel_hi:[0,1,1] neg_lo:[1,0,0]
    v_cvt_pk_bf16_f32 v215, v104, -v105
    v_cvt_pk_bf16_f32 v216, v106, -v107
    v_cvt_pk_bf16_f32 v217, v178, v179
    v_pk_mul_f32 v[94:95], v[100:101], v[102:103] op_sel_hi:[1,0]
    buffer_load_dwordx4 v52, s[40:43], s68 offen offset:1024 lds
    v_pk_mul_f32 v[98:99], v[108:109], v[102:103] op_sel_hi:[1,0]
    v_pk_mul_f32 v[106:107], v[104:105], v[102:103] op_sel_hi:[1,0]
    v_pk_mul_f32 v[180:181], v[178:179], v[96:97] op_sel_hi:[1,0]
    v_pk_fma_f32 v[94:95], v[100:101], v[102:103], v[94:95] op_sel:[1,1,0] op_sel_hi:[0,1,1] neg_lo:[1,0,0]
    v_pk_fma_f32 v[98:99], v[108:109], v[102:103], v[98:99] op_sel:[1,1,0] op_sel_hi:[0,1,1] neg_lo:[1,0,0]
    v_pk_fma_f32 v[106:107], v[104:105], v[102:103], v[106:107] op_sel:[1,1,0] op_sel_hi:[0,1,1] neg_lo:[1,0,0]
    v_pk_fma_f32 v[180:181], v[178:179], v[96:97], v[180:181] op_sel:[1,1,0] op_sel_hi:[0,1,1] neg_lo:[1,0,0]
    v_cvt_pk_bf16_f32 v218, v94, -v95
    v_cvt_pk_bf16_f32 v219, v98, -v99
    v_cvt_pk_bf16_f32 v220, v106, -v107
    v_cvt_pk_bf16_f32 v221, v180, v181
    v_lshlrev_b32 v12, 3, v0
    buffer_load_dwordx4 v53, s[40:43], s68 offen offset:2048 lds
    s_movk_i32 s63, 128
    v_sub_u32 v58, 2047, v12
    v_cvt_f32_u32 v13, v58
    v_cvt_pk_bf16_f32 v13, v13, v2
    v_add_u32 v13, -17024, v13
    v_med3_i32 v58, v13, v58, s63
    v_and_b32 v13, 7, v58
    v_ashrrev_i32 v58, 3, v58
    v_mul_u32_u24 v13, 400, v13
    v_lshl_add_u32 v58, v58, 2, v13
    v_sub_u32 v59, 2046, v12
    v_cvt_f32_u32 v13, v59
    buffer_load_dwordx4 v54, s[40:43], s68 offen offset:3072 lds
    v_cvt_pk_bf16_f32 v13, v13, v2
    v_add_u32 v13, -17024, v13
    v_med3_i32 v59, v13, v59, s63
    v_and_b32 v13, 7, v59
    v_ashrrev_i32 v59, 3, v59
    v_mul_u32_u24 v13, 400, v13
    v_lshl_add_u32 v59, v59, 2, v13
    v_sub_u32 v60, 2045, v12
    v_cvt_f32_u32 v13, v60
    v_cvt_pk_bf16_f32 v13, v13, v2
    v_add_u32 v13, -17024, v13
    v_med3_i32 v60, v13, v60, s63
    s_add_u32 s68, s68, 114688
    v_and_b32 v13, 7, v60
    v_ashrrev_i32 v60, 3, v60
    v_mul_u32_u24 v13, 400, v13
    v_lshl_add_u32 v60, v60, 2, v13
    v_sub_u32 v61, 2044, v12
    v_cvt_f32_u32 v13, v61
    v_cvt_pk_bf16_f32 v13, v13, v2
    v_add_u32 v13, -17024, v13
    v_med3_i32 v61, v13, v61, s63
    v_and_b32 v13, 7, v61
    v_ashrrev_i32 v61, 3, v61
    s_lshl2_add_u32 m0, s66, 102400
    v_mul_u32_u24 v13, 400, v13
    buffer_load_dwordx4 v51, s[40:43], s68 offen offset:0 lds
    v_lshl_add_u32 v61, v61, 2, v13
    v_sub_u32 v62, 2043, v12
    v_cvt_f32_u32 v13, v62
    v_cvt_pk_bf16_f32 v13, v13, v2
    v_add_u32 v13, -17024, v13
    v_med3_i32 v62, v13, v62, s63
    v_and_b32 v13, 7, v62
    v_ashrrev_i32 v62, 3, v62
    v_mul_u32_u24 v13, 400, v13
    v_lshl_add_u32 v62, v62, 2, v13
    v_sub_u32 v63, 2042, v12
    v_cvt_f32_u32 v13, v63
    buffer_load_dwordx4 v52, s[40:43], s68 offen offset:1024 lds
    v_cvt_pk_bf16_f32 v13, v13, v2
    v_add_u32 v13, -17024, v13
    v_med3_i32 v63, v13, v63, s63
    v_and_b32 v13, 7, v63
    v_ashrrev_i32 v63, 3, v63
    v_mul_u32_u24 v13, 400, v13
    v_lshl_add_u32 v63, v63, 2, v13
    v_sub_u32 v64, 2041, v12
    v_cvt_f32_u32 v13, v64
    v_cvt_pk_bf16_f32 v13, v13, v2
    v_add_u32 v13, -17024, v13
    v_med3_i32 v64, v13, v64, s63
    buffer_load_dwordx4 v53, s[40:43], s68 offen offset:2048 lds
    v_and_b32 v13, 7, v64
    v_ashrrev_i32 v64, 3, v64
    v_mul_u32_u24 v13, 400, v13
    v_lshl_add_u32 v64, v64, 2, v13
    v_sub_u32 v65, 2040, v12
    v_cvt_f32_u32 v13, v65
    v_cvt_pk_bf16_f32 v13, v13, v2
    v_add_u32 v13, -17024, v13
    v_med3_i32 v65, v13, v65, s63
    v_and_b32 v13, 7, v65
    v_ashrrev_i32 v65, 3, v65
    v_mul_u32_u24 v13, 400, v13
    buffer_load_dwordx4 v54, s[40:43], s68 offen offset:3072 lds
    v_lshl_add_u32 v65, v65, 2, v13
    v_sub_u32 v66, 2039, v12
    v_max_i32 v13, 0, v66
    v_cvt_f32_u32 v13, v13
    v_cvt_pk_bf16_f32 v13, v13, v2
    v_add_u32 v13, -17024, v13
    v_med3_i32 v66, v13, v66, s63
    v_and_b32 v13, 7, v66
    v_ashrrev_i32 v66, 3, v66
    v_mul_u32_u24 v13, 400, v13
    v_lshl_add_u32 v66, v66, 2, v13
    s_mov_b32 s0, 1
    s_mov_b64 exec, 0
    s_cmp_eq_u32 s58, 0
    s_cbranch_scc1 Lpg5
    s_cmp_eq_u32 s58, 1
    s_cbranch_scc1 Lpg3
    s_cmp_eq_u32 s58, 2
    s_cbranch_scc1 Lpg4
    s_branch Liw_ret_spare
Liw_ret_spare:
    s_mov_b64 exec, -1
    s_waitcnt vmcnt(9)
    s_barrier
    ds_read_b128 a[64:67], v76 offset:0
    ds_read_b128 a[68:71], v77 offset:0
    ds_read_b128 a[72:75], v78 offset:0
    ds_read_b128 a[76:79], v79 offset:0
    ds_read_b128 a[80:83], v76 offset:256
    s_waitcnt lgkmcnt(4)
    v_mfma_f32_16x16x32_bf16 v[142:145], a[64:67], a[64:67], 0
    ds_read_b128 a[84:87], v77 offset:256
    s_add_u32 s68, s68, 114688
    v_mfma_f32_16x16x32_bf16 v[146:149], v[158:161], a[64:67], 0
    ds_read_b128 a[88:91], v78 offset:256
    s_waitcnt lgkmcnt(5)
    v_mfma_f32_16x16x32_bf16 v[142:145], a[68:71], a[68:71], v[142:145]
    s_lshl2_add_u32 m0, s66, 106496
    ds_read_b128 a[92:95], v79 offset:256
    buffer_load_dwordx4 v51, s[40:43], s68 offen offset:0 lds
    v_mfma_f32_16x16x32_bf16 v[146:149], v[158:161], a[68:71], v[146:149]
    ds_read_b128 a[96:99], v76 offset:32768
    s_waitcnt lgkmcnt(6)
    v_mfma_f32_16x16x32_bf16 v[142:145], a[72:75], a[72:75], v[142:145]
    ds_read_b128 a[100:103], v77 offset:32768
    buffer_load_dwordx4 v52, s[40:43], s68 offen offset:1024 lds
    v_mfma_f32_16x16x32_bf16 v[146:149], v[158:161], a[72:75], v[146:149]
    ds_read_b128 a[104:107], v78 offset:32768
    s_waitcnt lgkmcnt(7)
    v_mfma_f32_16x16x32_bf16 v[142:145], a[76:79], a[76:79], v[142:145]
    ds_read_b128 a[108:111], v79 offset:32768
    buffer_load_dwordx4 v53, s[40:43], s68 offen offset:2048 lds
    v_mfma_f32_16x16x32_bf16 v[146:149], v[158:161], a[76:79], v[146:149]
    ds_read_b128 a[112:115], v76 offset:33024
    s_waitcnt lgkmcnt(8)
    v_mfma_f32_16x16x32_bf16 v[142:145], a[80:83], a[80:83], v[142:145]
    ds_read_b128 a[116:119], v77 offset:33024
    buffer_load_dwordx4 v54, s[40:43], s68 offen offset:3072 lds
    v_mfma_f32_16x16x32_bf16 v[146:149], v[158:161], a[80:83], v[146:149]
    ds_read_b128 a[120:123], v78 offset:33024
    s_waitcnt lgkmcnt(9)
    v_mfma_f32_16x16x32_bf16 v[142:145], a[84:87], a[84:87], v[142:145]
    ds_read_b128 a[124:127], v79 offset:33024
    s_add_u32 s68, s68, 114688
    v_mfma_f32_16x16x32_bf16 v[146:149], v[158:161], a[84:87], v[146:149]
    s_lshl2_add_u32 m0, s66, 110592
    s_waitcnt lgkmcnt(9)
    v_mfma_f32_16x16x32_bf16 v[142:145], a[88:91], a[88:91], v[142:145]
    buffer_load_dwordx4 v51, s[40:43], s68 offen offset:0 lds
    v_mfma_f32_16x16x32_bf16 v[146:149], v[158:161], a[88:91], v[146:149]
    s_waitcnt lgkmcnt(8)
    v_mfma_f32_16x16x32_bf16 v[142:145], a[92:95], a[92:95], v[142:145]
    buffer_load_dwordx4 v52, s[40:43], s68 offen offset:1024 lds
    v_mfma_f32_16x16x32_bf16 v[146:149], v[158:161], a[92:95], v[146:149]
    s_waitcnt lgkmcnt(7)
    v_mfma_f32_16x16x32_bf16 v[142:145], a[96:99], a[96:99], v[142:145]
    buffer_load_dwordx4 v53, s[40:43], s68 offen offset:2048 lds
    v_mfma_f32_16x16x32_bf16 v[146:149], v[158:161], a[96:99], v[146:149]
    s_waitcnt lgkmcnt(6)
    v_mfma_f32_16x16x32_bf16 v[142:145], a[100:103], a[100:103], v[142:145]
    buffer_load_dwordx4 v54, s[40:43], s68 offen offset:3072 lds
    v_mfma_f32_16x16x32_bf16 v[146:149], v[158:161], a[100:103], v[146:149]
    s_waitcnt lgkmcnt(5)
    v_mfma_f32_16x16x32_bf16 v[142:145], a[104:107], a[104:107], v[142:145]
    global_load_ushort v55, v55, s[22:23]
    v_mfma_f32_16x16x32_bf16 v[146:149], v[158:161], a[104:107], v[146:149]
    s_mov_b32 m0, 16384
    s_waitcnt lgkmcnt(4)
    v_mfma_f32_16x16x32_bf16 v[142:145], a[108:111], a[108:111], v[142:145]
    global_load_lds_dwordx4 v20, s[28:29]
    v_mfma_f32_16x16x32_bf16 v[146:149], v[158:161], a[108:111], v[146:149]
    s_waitcnt lgkmcnt(3)
    v_mfma_f32_16x16x32_bf16 v[142:145], a[112:115], a[112:115], v[142:145]
    v_mfma_f32_16x16x32_bf16 v[146:149], v[158:161], a[112:115], v[146:149]
    s_waitcnt lgkmcnt(2)
    v_mfma_f32_16x16x32_bf16 v[142:145], a[116:119], a[116:119], v[142:145]
    v_mfma_f32_16x16x32_bf16 v[146:149], v[158:161], a[116:119], v[146:149]
    s_waitcnt lgkmcnt(1)
    v_mfma_f32_16x16x32_bf16 v[142:145], a[120:123], a[120:123], v[142:145]
    v_mfma_f32_16x16x32_bf16 v[146:149], v[158:161], a[120:123], v[146:149]
    s_waitcnt lgkmcnt(0)
    v_mfma_f32_16x16x32_bf16 v[142:145], a[124:127], a[124:127], v[142:145]
    v_mfma_f32_16x16x32_bf16 v[146:149], v[158:161], a[124:127], v[146:149]
    v_perm_b32 v134, v127, v126, s18
    v_perm_b32 v135, v129, v128, s18
    v_perm_b32 v136, v131, v130, s18
    v_perm_b32 v137, v133, v132, s18
    v_perm_b32 v138, v127, v126, s19
    v_perm_b32 v139, v129, v128, s19
    v_perm_b32 v140, v131, v130, s19
    v_perm_b32 v141, v133, v132, s19
    buffer_store_dwordx4 v[134:137], v40, s[48:51], s98 offen sc1
    buffer_store_dwordx4 v[138:141], v40, s[48:51], s3 offen sc1
    s_waitcnt vmcnt(20)
    v_readfirstlane_b32 s64, v6
    s_nop 1
    s_cmp_eq_u32 s64, 0
    s_cbranch_scc1 Lretry4
Lback4:
    s_mov_b32 s65, s64
    v_and_b32 v8, 1, v1
    v_cmp_eq_u32 vcc, 1, v8
    v_and_b32 v8, 2, v1
    v_cmp_eq_u32 s[60:61], 2, v8
    v_cndmask_b32 v142, v142, v143, vcc
    v_cndmask_b32 v144, v144, v145, vcc
    v_cndmask_b32 v142, v142, v144, s[60:61]
    v_mul_f32 v146, 0x3b000000, v146
    v_mul_f32 v142, 0x3b000000, v142
    v_fma_f32 v142, -v146, v146, v142
    v_mul_f32 v146, 0x3e800000, v146
    v_cvt_pk_bf16_f32 v86, -v146, -v146
    v_max_f32 v142, 0, v142
    v_add_f32 v142, 0x3727c5ac, v142
    v_and_b32 v148, 0xffff0000, v86
    v_sqrt_f32 v92, v142
    v_rsq_f32 v143, v142
    v_add_f32 v148, v148, v146
    v_mul_f32 v90, 0xc0135761, v143
    v_mul_f32 v144, v143, v143
    v_mul_f32 v91, 0xbdd2d3e8, v143
    v_mul_f32 v91, v91, v144
    v_mul_f32 v149, 0x3e800000, v92
    v_cvt_pk_bf16_f32 v147, v149, v149
    v_and_b32 v147, 0xffff0000, v147
    v_sub_f32 v149, v149, v147
    v_cvt_pk_bf16_f32 v87, -v148, v147
    v_cvt_pk_bf16_f32 v88, v149, v2
    v_mov_b32 v89, s64
    v_mov_b32 v93, s64
    buffer_store_dwordx4 v[86:89], v85, s[48:51], s72 offen sc1
    buffer_store_dwordx4 v[90:93], v85, s[48:51], s73 offen sc1
    s_lshl2_add_u32 s61, s2, s58
    s_mul_i32 s61, s61, 1792
    v_lshlrev_b32 v15, 7, v4
    s_lshl2_add_u32 s62, s57, s58
    s_mul_i32 s62, s62, 14336
    v_min_u32 v57, 13, v1
    v_lshlrev_b32 v57, 10, v57
    buffer_load_dword v7, v15, s[44:47], s61 offen
    s_waitcnt vmcnt(5)
    s_barrier
    ds_read_b64_tr_b16 a[0:1], v81 offset:0
    ds_read_b64_tr_b16 a[2:3], v81 offset:2048
    ds_read_b64_tr_b16 a[4:5], v81 offset:4096
    ds_read_b64_tr_b16 a[6:7], v81 offset:6144
    ds_read_b64_tr_b16 a[8:9], v81 offset:8192
    ds_read_b64_tr_b16 a[10:11], v81 offset:10240
    ds_read_b64_tr_b16 a[12:13], v81 offset:12288
    ds_read_b64_tr_b16 a[14:15], v81 offset:14336
    ds_read_b64_tr_b16 a[16:17], v81 offset:16384
Lpg5:
    s_cbranch_execz Liw_ret_spare
    ds_read_b64_tr_b16 a[18:19], v81 offset:18432
    ds_read_b64_tr_b16 a[20:21], v81 offset:20480
    ds_read_b64_tr_b16 a[22:23], v81 offset:22528
    ds_read_b64_tr_b16 a[24:25], v81 offset:24576
    ds_read_b64_tr_b16 a[26:27], v81 offset:26624
    ds_read_b64_tr_b16 a[28:29], v81 offset:28672
    ds_read_b64_tr_b16 a[30:31], v81 offset:30720
    s_waitcnt lgkmcnt(14)
    v_mfma_f32_16x16x32_bf16 v[154:157], v[158:161], a[0:3], 0
    ds_read_b64_tr_b16 a[32:33], v81 offset:32768
    ds_read_b64_tr_b16 a[34:35], v81 offset:34816
    s_waitcnt lgkmcnt(14)
    v_mfma_f32_16x16x32_bf16 v[154:157], v[158:161], a[4:7], v[154:157]
    ds_read_b64_tr_b16 a[36:37], v81 offset:36864
    ds_read_b64_tr_b16 a[38:39], v81 offset:38912
    s_waitcnt lgkmcnt(14)
    v_mfma_f32_16x16x32_bf16 v[154:157], v[158:161], a[8:11], v[154:157]
    ds_read_b64_tr_b16 a[40:41], v81 offset:40960
    ds_read_b64_tr_b16 a[42:43], v81 offset:43008
    s_waitcnt lgkmcnt(14)
    v_mfma_f32_16x16x32_bf16 v[154:157], v[158:161], a[12:15], v[154:157]
    ds_read_b64_tr_b16 a[44:45], v81 offset:45056
    ds_read_b64_tr_b16 a[46:47], v81 offset:47104
    s_waitcnt lgkmcnt(14)
    v_mfma_f32_16x16x32_bf16 v[154:157], v[158:161], a[16:19], v[154:157]
    ds_read_b64_tr_b16 a[48:49], v81 offset:49152
    ds_read_b64_tr_b16 a[50:51], v81 offset:51200
    s_waitcnt lgkmcnt(14)
    v_mfma_f32_16x16x32_bf16 v[154:157], v[158:161], a[20:23], v[154:157]
    ds_read_b64_tr_b16 a[52:53], v81 offset:53248
    ds_read_b64_tr_b16 a[54:55], v81 offset:55296
    s_waitcnt lgkmcnt(14)
    v_mfma_f32_16x16x32_bf16 v[154:157], v[158:161], a[24:27], v[154:157]
    ds_read_b64_tr_b16 a[56:57], v81 offset:57344
    ds_read_b64_tr_b16 a[58:59], v81 offset:59392
    s_waitcnt lgkmcnt(14)
    v_mfma_f32_16x16x32_bf16 v[154:157], v[158:161], a[28:31], v[154:157]
    ds_read_b64_tr_b16 a[60:61], v81 offset:61440
    ds_read_b64_tr_b16 a[62:63], v81 offset:63488
    s_waitcnt lgkmcnt(14)
    v_mfma_f32_16x16x32_bf16 v[154:157], v[158:161], a[32:35], v[154:157]
    ds_read_b128 a[128:131], v80 offset:0
    ds_read_b128 a[132:135], v80 offset:64
    s_waitcnt lgkmcnt(14)
    v_mfma_f32_16x16x32_bf16 v[154:157], v[158:161], a[36:39], v[154:157]
    ds_read_b128 a[136:139], v80 offset:128
    ds_read_b128 a[140:143], v80 offset:192
    s_waitcnt lgkmcnt(14)
    v_mfma_f32_16x16x32_bf16 v[154:157], v[158:161], a[40:43], v[154:157]
    ds_read_b128 a[144:147], v80 offset:256
    ds_read_b128 a[148:151], v80 offset:320
    s_waitcnt lgkmcnt(14)
    v_mfma_f32_16x16x32_bf16 v[154:157], v[158:161], a[44:47], v[154:157]
    ds_read_b128 a[152:155], v80 offset:384
    ds_read_b128 a[156:159], v80 offset:448
    s_waitcnt lgkmcnt(14)
    v_mfma_f32_16x16x32_bf16 v[154:157], v[158:161], a[48:51], v[154:157]
    ds_read_b128 a[160:163], v80 offset:512
    ds_read_b128 a[164:167], v80 offset:576
    s_waitcnt lgkmcnt(14)
    v_mfma_f32_16x16x32_bf16 v[154:157], v[158:161], a[52:55], v[154:157]
    ds_read_b128 a[168:171], v80 offset:640
    ds_read_b128 a[172:175], v80 offset:704
    s_waitcnt lgkmcnt(14)
    v_mfma_f32_16x16x32_bf16 v[154:157], v[158:161], a[56:59], v[154:157]
    ds_read_b128 a[176:179], v80 offset:768
    ds_read_b128 a[180:183], v80 offset:832
    s_waitcnt lgkmcnt(14)
    v_mfma_f32_16x16x32_bf16 v[154:157], v[158:161], a[60:63], v[154:157]
    ds_read_b128 a[184:187], v80 offset:896
    ds_read_b128 a[188:191], v80 offset:960
    v_cmp_gt_u32 vcc, 16, v1
    v_mov_b32 v10, 0x7ff00000
    s_lshl2_add_u32 s60, s76, s58
    s_lshl_b32 s60, s60, 8
    s_add_u32 s60, s60, 622592
    v_cndmask_b32 v8, v10, v20, vcc
    v_mov_b32 v88, v55
    v_cvt_pk_bf16_f32 v87, v154, v2
    v_lshlrev_b32 v11, 16, v87
    v_lshl_or_b32 v87, v55, 16, v87
    v_sub_f32 v12, v154, v11
    v_cvt_pk_bf16_f32 v86, v11, v12
    buffer_store_dwordx4 v[86:89], v8, s[48:51], s60 offen sc1
    s_waitcnt lgkmcnt(15)
    v_mfma_f32_16x16x32_bf16 v[150:153], a[128:131], a[64:67], 0
    s_waitcnt lgkmcnt(14)
    v_mfma_f32_16x16x32_bf16 v[150:153], a[132:135], a[68:71], v[150:153]
    s_waitcnt lgkmcnt(13)
    v_mfma_f32_16x16x32_bf16 v[150:153], a[136:139], a[72:75], v[150:153]
    s_waitcnt lgkmcnt(12)
    v_mfma_f32_16x16x32_bf16 v[150:153], a[140:143], a[76:79], v[150:153]
    s_waitcnt lgkmcnt(11)
    v_mfma_f32_16x16x32_bf16 v[150:153], a[144:147], a[80:83], v[150:153]
    s_waitcnt lgkmcnt(10)
    v_mfma_f32_16x16x32_bf16 v[150:153], a[148:151], a[84:87], v[150:153]
    s_waitcnt lgkmcnt(9)
    v_mfma_f32_16x16x32_bf16 v[150:153], a[152:155], a[88:91], v[150:153]
    s_waitcnt lgkmcnt(8)
    v_mfma_f32_16x16x32_bf16 v[150:153], a[156:159], a[92:95], v[150:153]
    s_waitcnt lgkmcnt(7)
    v_mfma_f32_16x16x32_bf16 v[150:153], a[160:163], a[96:99], v[150:153]
    s_waitcnt lgkmcnt(6)
    v_mfma_f32_16x16x32_bf16 v[150:153], a[164:167], a[100:103], v[150:153]
    s_waitcnt lgkmcnt(5)
    v_mfma_f32_16x16x32_bf16 v[150:153], a[168:171], a[104:107], v[150:153]
    s_waitcnt lgkmcnt(4)
    v_mfma_f32_16x16x32_bf16 v[150:153], a[172:175], a[108:111], v[150:153]
    s_waitcnt lgkmcnt(3)
    v_mfma_f32_16x16x32_bf16 v[150:153], a[176:179], a[112:115], v[150:153]
    s_waitcnt lgkmcnt(2)
    v_mfma_f32_16x16x32_bf16 v[150:153], a[180:183], a[116:119], v[150:153]
    s_waitcnt lgkmcnt(1)
    v_mfma_f32_16x16x32_bf16 v[150:153], a[184:187], a[120:123], v[150:153]
    s_waitcnt lgkmcnt(0)
    v_mfma_f32_16x16x32_bf16 v[150:153], a[188:191], a[124:127], v[150:153]
    s_lshl_b32 s62, s75, 9
    s_add_u32 s62, s62, 589824
    v_lshrrev_b32 v9, 1, v85
    s_nop 4
    v_mul_f32 v150, 0xbfb8aa3b, v150
    v_exp_f32 v150, v150
    s_nop 0
    v_add_f32 v150, 1.0, v150
    v_rcp_f32 v92, v150
    s_nop 0
    buffer_store_dwordx2 v[92:93], v9, s[48:51], s62 offen sc1
    s_waitcnt vmcnt(5)
    s_barrier
    s_cmp_lg_u32 s58, 0
    s_cbranch_scc1 Lback5
    s_atomic_swap s64, s[34:35], s99
Lback5:
    s_and_b32 s60, s57, 3
    s_lshl2_add_u32 s60, s60, s58
    s_mul_i32 s60, s60, 114688
    s_add_u32 s61, s60, 57344
    v_min_u32 v8, 55, v1
    v_lshlrev_b32 v8, 10, v8
    buffer_load_dword v7, v8, s[44:47], s60 offen offset:384
    buffer_load_dword v7, v8, s[44:47], s61 offen offset:384
    s_mul_i32 s77, s58, 458752
    s_lshl_b32 s60, s81, 7
    s_add_u32 s77, s77, s60
    s_sub_u32 s77, s77, 32768
    s_lshr_b32 s60, s58, 1
    s_lshl1_add_u32 s82, s2, s60
    v_lshlrev_b32 v10, 1, v5
    v_and_b32 v11, 7, v1
    v_xor_b32 v10, v10, v11
    v_lshrrev_b32 v11, 3, v1
    v_lshlrev_b32 v11, 10, v11
    v_lshl_add_u32 v25, v10, 4, v11
    v_add_u32 v26, 7168, v25
    v_add_u32 v27, 14336, v25
    v_add_u32 v28, 21504, v25
    v_lshrrev_b32 v10, 2, v1
    v_lshlrev_b32 v10, 7, v10
    v_and_b32 v11, 3, v1
    v_lshl_add_u32 v10, v11, 3, v10
    v_bfe_u32 v11, v1, 3, 2
    v_lshl_add_u32 v10, v11, 5, v10
    s_add_u32 s60, s66, 65536
    v_add_u32 v29, s60, v10
    s_sub_u32 s60, s66, 32768
    v_add_u32 v33, s60, v29
    v_xor_b32 v30, 32, v29
    v_add_u32 v34, s60, v30
    v_xor_b32 v31, 64, v29
    v_add_u32 v35, s60, v31
    v_xor_b32 v32, 96, v29
    v_add_u32 v36, s60, v32
    v_and_b32 v12, 1, v1
    v_lshrrev_b32 v13, 1, v4
    s_and_b32 s60, s58, 2
    s_lshl_b32 s60, s60, 13
    s_lshl_b32 s62, s59, 8
    s_sub_u32 s60, s60, s62
    s_add_u32 s61, s60, 312
    v_mul_u32_u24 v37, 8320, v12
    v_lshl_add_u32 v37, v5, 4, v37
    v_lshlrev_b32 v14, 3, v13
    v_sub_u32 v37, v37, v14
    v_add_u32 v37, s61, v37
    s_add_u32 s61, s60, 33088
    v_mul_u32_u24 v38, 8224, v12
    v_lshl_add_u32 v38, v5, 4, v38
    v_lshl_add_u32 v38, v13, 6, v38
    v_add_u32 v38, s61, v38
    s_lshr_b32 s13, s2, 5
    s_lshl_b32 s13, s13, 9
    s_add_u32 s13, s13, 65536
    v_and_b32 v24, 31, v1
    v_lshlrev_b32 v24, 4, v24
    s_lshl_b32 s60, s82, 12
    s_lshl_b32 s61, s59, 2
    s_sub_u32 s60, s60, s61
    s_add_u32 s4, s60, 2097152
    s_lshl_b32 s61, s59, 5
    s_add_u32 s5, s78, s61
    v_lshl_add_u32 v39, v1, 3, s5
    s_lshl2_add_u32 s60, s59, s5
    s_mov_b32 m0, s78
    v_mov_b32 v40, s60
    ds_write_addtid_b32 v198 offset:0
    ds_write_addtid_b32 v199 offset:272
    ds_write_addtid_b32 v201 offset:544
    ds_write_addtid_b32 v203 offset:816
    ds_write_addtid_b32 v204 offset:1088
    ds_write_addtid_b32 v206 offset:1360
    ds_write_addtid_b32 v207 offset:1632
    ds_write_addtid_b32 v209 offset:1904
    v_pk_mul_f32 v[182:183], v[162:163], v[164:165] op_sel_hi:[1,0]
    v_pk_mul_f32 v[184:185], v[168:169], v[164:165] op_sel_hi:[1,0]
    v_pk_mul_f32 v[186:187], v[170:171], v[164:165] op_sel_hi:[1,0]
    v_pk_mul_f32 v[188:189], v[172:173], v[164:165] op_sel_hi:[1,0]
    v_pk_fma_f32 v[182:183], v[162:163], v[164:165], v[182:183] op_sel:[1,1,0] op_sel_hi:[0,1,1] neg_lo:[1,0,0]
    v_pk_fma_f32 v[184:185], v[168:169], v[164:165], v[184:185] op_sel:[1,1,0] op_sel_hi:[0,1,1] neg_lo:[1,0,0]
    ds_write_addtid_b32 v210 offset:2176
    ds_write_addtid_b32 v212 offset:2448
    ds_write_addtid_b32 v213 offset:2720
    ds_write_addtid_b32 v215 offset:2992
    ds_write_addtid_b32 v216 offset:3264
    ds_write_addtid_b32 v218 offset:3536
    ds_write_addtid_b32 v219 offset:3808
    ds_write_addtid_b32 v220 offset:4080
    v_pk_fma_f32 v[186:187], v[170:171], v[164:165], v[186:187] op_sel:[1,1,0] op_sel_hi:[0,1,1] neg_lo:[1,0,0]
    v_pk_fma_f32 v[188:189], v[172:173], v[164:165], v[188:189] op_sel:[1,1,0] op_sel_hi:[0,1,1] neg_lo:[1,0,0]
    v_cvt_pk_bf16_f32 v222, v182, v183
    v_cvt_pk_bf16_f32 v223, v184, v185
    v_cvt_pk_bf16_f32 v224, v186, v187
    v_cvt_pk_bf16_f32 v225, v188, v189
    v_pk_mul_f32 v[168:169], v[174:175], v[164:165] op_sel_hi:[1,0]
    v_pk_mul_f32 v[172:173], v[176:177], v[164:165] op_sel_hi:[1,0]
    v_pk_mul_f32 v[184:185], v[178:179], v[164:165] op_sel_hi:[1,0]
    v_pk_mul_f32 v[188:189], v[180:181], v[164:165] op_sel_hi:[1,0]
    v_pk_fma_f32 v[168:169], v[174:175], v[164:165], v[168:169] op_sel:[1,1,0] op_sel_hi:[0,1,1] neg_lo:[1,0,0]
    v_pk_fma_f32 v[172:173], v[176:177], v[164:165], v[172:173] op_sel:[1,1,0] op_sel_hi:[0,1,1] neg_lo:[1,0,0]
    v_pk_fma_f32 v[184:185], v[178:179], v[164:165], v[184:185] op_sel:[1,1,0] op_sel_hi:[0,1,1] neg_lo:[1,0,0]
    v_pk_fma_f32 v[188:189], v[180:181], v[164:165], v[188:189] op_sel:[1,1,0] op_sel_hi:[0,1,1] neg_lo:[1,0,0]
    ds_read_b128 a[160:163], v72 offset:0
    ds_read_b128 a[164:167], v72 offset:64
    ds_read_b128 a[168:171], v72 offset:128
    ds_read_b128 a[172:175], v72 offset:192
    v_cvt_pk_bf16_f32 v226, v168, v169
    v_cvt_pk_bf16_f32 v227, v172, v173
    v_cvt_pk_bf16_f32 v228, v184, v185
    v_cvt_pk_bf16_f32 v229, v188, v189
    ds_write_addtid_b32 v200 offset:0
    ds_write_addtid_b32 v202 offset:272
    ds_write_addtid_b32 v205 offset:544
    ds_write_addtid_b32 v208 offset:816
    v_pk_mul_f32 v[164:165], v[162:163], v[166:167] op_sel_hi:[1,0]
    v_pk_mul_f32 v[172:173], v[170:171], v[166:167] op_sel_hi:[1,0]
    v_pk_mul_f32 v[176:177], v[174:175], v[166:167] op_sel_hi:[1,0]
    v_pk_mul_f32 v[180:181], v[178:179], v[166:167] op_sel_hi:[1,0]
    v_pk_fma_f32 v[164:165], v[162:163], v[166:167], v[164:165] op_sel:[1,1,0] op_sel_hi:[0,1,1] neg_lo:[1,0,0]
    v_pk_fma_f32 v[172:173], v[170:171], v[166:167], v[172:173] op_sel:[1,1,0] op_sel_hi:[0,1,1] neg_lo:[1,0,0]
    v_pk_fma_f32 v[176:177], v[174:175], v[166:167], v[176:177] op_sel:[1,1,0] op_sel_hi:[0,1,1] neg_lo:[1,0,0]
    v_pk_fma_f32 v[180:181], v[178:179], v[166:167], v[180:181] op_sel:[1,1,0] op_sel_hi:[0,1,1] neg_lo:[1,0,0]
    ds_write_addtid_b32 v211 offset:1088
    ds_write_addtid_b32 v214 offset:1360
    ds_write_addtid_b32 v217 offset:1632
    ds_write_addtid_b32 v221 offset:1904
    v_cvt_pk_bf16_f32 v198, v164, v165
    v_cvt_pk_bf16_f32 v199, v172, v173
    v_cvt_pk_bf16_f32 v201, v176, v177
    v_cvt_pk_bf16_f32 v203, v180, v181
    v_pk_mul_f32 v[162:163], v[182:183], v[166:167] op_sel_hi:[1,0]
    v_pk_mul_f32 v[170:171], v[186:187], v[166:167] op_sel_hi:[1,0]
    v_pk_mul_f32 v[172:173], v[168:169], v[166:167] op_sel_hi:[1,0]
    v_pk_mul_f32 v[174:175], v[184:185], v[166:167] op_sel_hi:[1,0]
    ds_write_addtid_b32 v222 offset:2176
    ds_write_addtid_b32 v223 offset:2448
    ds_write_addtid_b32 v224 offset:2720
    ds_write_addtid_b32 v225 offset:2992
    v_pk_mul_f32 v[178:179], v[166:167], v[166:167] op_sel_hi:[1,0]
    v_pk_fma_f32 v[162:163], v[182:183], v[166:167], v[162:163] op_sel:[1,1,0] op_sel_hi:[0,1,1] neg_lo:[1,0,0]
    v_pk_fma_f32 v[170:171], v[186:187], v[166:167], v[170:171] op_sel:[1,1,0] op_sel_hi:[0,1,1] neg_lo:[1,0,0]
    v_pk_fma_f32 v[172:173], v[168:169], v[166:167], v[172:173] op_sel:[1,1,0] op_sel_hi:[0,1,1] neg_lo:[1,0,0]
    v_pk_fma_f32 v[174:175], v[184:185], v[166:167], v[174:175] op_sel:[1,1,0] op_sel_hi:[0,1,1] neg_lo:[1,0,0]
    v_pk_fma_f32 v[178:179], v[166:167], v[166:167], v[178:179] op_sel:[1,1,0] op_sel_hi:[0,1,1] neg_lo:[1,0,0]
    v_cvt_pk_bf16_f32 v204, v162, v163
    v_cvt_pk_bf16_f32 v206, v170, v171
    ds_write_addtid_b32 v226 offset:3264
    ds_write_addtid_b32 v227 offset:3536
    ds_write_addtid_b32 v228 offset:3808
    ds_write_addtid_b32 v229 offset:4080
    v_cvt_pk_bf16_f32 v207, v172, v173
    v_cvt_pk_bf16_f32 v209, v174, v175
    v_pk_mul_f32 v[168:169], v[164:165], v[166:167] op_sel_hi:[1,0]
    v_pk_mul_f32 v[170:171], v[176:177], v[166:167] op_sel_hi:[1,0]
    v_pk_mul_f32 v[174:175], v[162:163], v[166:167] op_sel_hi:[1,0]
    v_pk_mul_f32 v[180:181], v[172:173], v[166:167] op_sel_hi:[1,0]
    v_pk_fma_f32 v[168:169], v[164:165], v[166:167], v[168:169] op_sel:[1,1,0] op_sel_hi:[0,1,1] neg_lo:[1,0,0]
    v_pk_fma_f32 v[170:171], v[176:177], v[166:167], v[170:171] op_sel:[1,1,0] op_sel_hi:[0,1,1] neg_lo:[1,0,0]
    v_pk_fma_f32 v[174:175], v[162:163], v[166:167], v[174:175] op_sel:[1,1,0] op_sel_hi:[0,1,1] neg_lo:[1,0,0]
    v_pk_fma_f32 v[180:181], v[172:173], v[166:167], v[180:181] op_sel:[1,1,0] op_sel_hi:[0,1,1] neg_lo:[1,0,0]
    v_cvt_pk_bf16_f32 v210, v168, v169
    v_cvt_pk_bf16_f32 v212, v170, v171
    v_cvt_pk_bf16_f32 v213, v174, v175
    v_cvt_pk_bf16_f32 v215, v180, v181
    v_pk_mul_f32 v[182:183], v[164:165], v[178:179] op_sel_hi:[1,0]
    v_pk_mul_f32 v[184:185], v[176:177], v[178:179] op_sel_hi:[1,0]
    ds_read_b128 a[176:179], v72 offset:0
    ds_read_b128 a[180:183], v72 offset:64
    ds_read_b128 a[184:187], v72 offset:128
    ds_read_b128 a[188:191], v72 offset:192
    v_pk_mul_f32 v[186:187], v[162:163], v[178:179] op_sel_hi:[1,0]
    v_pk_mul_f32 v[188:189], v[172:173], v[178:179] op_sel_hi:[1,0]
    v_pk_fma_f32 v[182:183], v[164:165], v[178:179], v[182:183] op_sel:[1,1,0] op_sel_hi:[0,1,1] neg_lo:[1,0,0]
    v_pk_fma_f32 v[184:185], v[176:177], v[178:179], v[184:185] op_sel:[1,1,0] op_sel_hi:[0,1,1] neg_lo:[1,0,0]
    v_pk_fma_f32 v[186:187], v[162:163], v[178:179], v[186:187] op_sel:[1,1,0] op_sel_hi:[0,1,1] neg_lo:[1,0,0]
    v_pk_fma_f32 v[188:189], v[172:173], v[178:179], v[188:189] op_sel:[1,1,0] op_sel_hi:[0,1,1] neg_lo:[1,0,0]
    v_cvt_pk_bf16_f32 v216, v182, v183
    v_cvt_pk_bf16_f32 v218, v184, v185
    v_cvt_pk_bf16_f32 v219, v186, v187
    v_cvt_pk_bf16_f32 v220, v188, v189
    ds_write_addtid_b32 v198 offset:0
    ds_write_addtid_b32 v199 offset:272
    ds_write_addtid_b32 v201 offset:544
    ds_write_addtid_b32 v203 offset:816
    v_pk_mul_f32 v[162:163], v[168:169], v[178:179] op_sel_hi:[1,0]
    v_pk_mul_f32 v[164:165], v[174:175], v[178:179] op_sel_hi:[1,0]
    v_pk_mul_f32 v[166:167], v[182:183], v[178:179] op_sel_hi:[1,0]
    v_pk_mul_f32 v[170:171], v[186:187], v[178:179] op_sel_hi:[1,0]
    v_pk_fma_f32 v[162:163], v[168:169], v[178:179], v[162:163] op_sel:[1,1,0] op_sel_hi:[0,1,1] neg_lo:[1,0,0]
    v_pk_fma_f32 v[164:165], v[174:175], v[178:179], v[164:165] op_sel:[1,1,0] op_sel_hi:[0,1,1] neg_lo:[1,0,0]
    v_pk_fma_f32 v[166:167], v[182:183], v[178:179], v[166:167] op_sel:[1,1,0] op_sel_hi:[0,1,1] neg_lo:[1,0,0]
    v_pk_fma_f32 v[170:171], v[186:187], v[178:179], v[170:171] op_sel:[1,1,0] op_sel_hi:[0,1,1] neg_lo:[1,0,0]
    ds_write_addtid_b32 v204 offset:1088
    ds_write_addtid_b32 v206 offset:1360
    ds_write_addtid_b32 v207 offset:1632
    ds_write_addtid_b32 v209 offset:1904
    v_cvt_pk_bf16_f32 v200, v162, v163
    v_cvt_pk_bf16_f32 v202, v164, v165
    v_cvt_pk_bf16_f32 v205, v166, v167
    v_cvt_pk_bf16_f32 v208, v170, v171
    v_pk_mul_f32 v[168:169], v[162:163], v[178:179] op_sel_hi:[1,0]
    v_pk_mul_f32 v[172:173], v[164:165], v[178:179] op_sel_hi:[1,0]
    v_pk_mul_f32 v[174:175], v[166:167], v[178:179] op_sel_hi:[1,0]
    v_pk_mul_f32 v[176:177], v[170:171], v[178:179] op_sel_hi:[1,0]
    ds_write_addtid_b32 v210 offset:2176
    ds_write_addtid_b32 v212 offset:2448
    ds_write_addtid_b32 v213 offset:2720
    ds_write_addtid_b32 v215 offset:2992
    v_pk_fma_f32 v[168:169], v[162:163], v[178:179], v[168:169] op_sel:[1,1,0] op_sel_hi:[0,1,1] neg_lo:[1,0,0]
    v_pk_fma_f32 v[172:173], v[164:165], v[178:179], v[172:173] op_sel:[1,1,0] op_sel_hi:[0,1,1] neg_lo:[1,0,0]
    v_pk_fma_f32 v[174:175], v[166:167], v[178:179], v[174:175] op_sel:[1,1,0] op_sel_hi:[0,1,1] neg_lo:[1,0,0]
    v_pk_fma_f32 v[176:177], v[170:171], v[178:179], v[176:177] op_sel:[1,1,0] op_sel_hi:[0,1,1] neg_lo:[1,0,0]
    v_cvt_pk_bf16_f32 v211, v168, v169
    v_cvt_pk_bf16_f32 v214, v172, v173
    v_cvt_pk_bf16_f32 v217, v174, v175
    v_cvt_pk_bf16_f32 v221, v176, v177
    ds_write_addtid_b32 v216 offset:3264
    ds_write_addtid_b32 v218 offset:3536
    ds_write_addtid_b32 v219 offset:3808
    ds_write_addtid_b32 v220 offset:4080
    v_pk_mul_f32 v[162:163], v[168:169], v[178:179] op_sel_hi:[1,0]
    v_pk_fma_f32 v[162:163], v[168:169], v[178:179], v[162:163] op_sel:[1,1,0] op_sel_hi:[0,1,1] neg_lo:[1,0,0]
    v_cvt_pk_bf16_f32 v222, v162, v163
    ds_write_addtid_b32 v200 offset:4352
    ds_write_addtid_b32 v202 offset:4624
    ds_write_addtid_b32 v205 offset:4896
    ds_write_addtid_b32 v208 offset:5168
    ds_write_addtid_b32 v211 offset:5440
    ds_write_addtid_b32 v214 offset:5712
    ds_write_addtid_b32 v217 offset:5984
    ds_write_addtid_b32 v221 offset:6256
    ds_write_addtid_b32 v222 offset:6528
    s_waitcnt lgkmcnt(15)
    v_mfma_f32_16x16x32_bf16 a[224:227], a[176:179], a[160:163], a[224:227]
    v_mfma_f32_16x16x32_bf16 a[224:227], a[180:183], a[164:167], a[224:227]
    v_mfma_f32_16x16x32_bf16 a[224:227], a[184:187], a[168:171], a[224:227]
    v_mfma_f32_16x16x32_bf16 a[224:227], a[188:191], a[172:175], a[224:227]
    ds_read_b128 a[192:195], v72 offset:0
    ds_read_b128 a[196:199], v72 offset:64
    ds_read_b128 a[200:203], v72 offset:128
    ds_read_b128 a[204:207], v72 offset:192
    ds_read_b128 a[208:211], v72 offset:4352
    ds_read_b128 a[212:215], v72 offset:4416
    ds_read_b128 a[216:219], v72 offset:4480
    ds_read_b128 a[220:223], v72 offset:4544
    s_waitcnt lgkmcnt(7)
    v_mfma_f32_16x16x32_bf16 a[228:231], a[192:195], a[160:163], 0
    s_waitcnt lgkmcnt(6)
    v_mfma_f32_16x16x32_bf16 a[228:231], a[196:199], a[164:167], a[228:231]
    s_waitcnt lgkmcnt(5)
    v_mfma_f32_16x16x32_bf16 a[228:231], a[200:203], a[168:171], a[228:231]
    s_waitcnt lgkmcnt(4)
    v_mfma_f32_16x16x32_bf16 a[228:231], a[204:207], a[172:175], a[228:231]
    s_waitcnt lgkmcnt(3)
    v_mfma_f32_16x16x32_bf16 a[232:235], a[208:211], a[160:163], 0
    s_waitcnt lgkmcnt(2)
    v_mfma_f32_16x16x32_bf16 a[232:235], a[212:215], a[164:167], a[232:235]
    s_waitcnt lgkmcnt(1)
    v_mfma_f32_16x16x32_bf16 a[232:235], a[216:219], a[168:171], a[232:235]
    s_waitcnt lgkmcnt(0)
    v_mfma_f32_16x16x32_bf16 a[232:235], a[220:223], a[172:175], a[232:235]
    ds_write_b32 v75, v2 offset:2796
    ds_write2_b32 v67, a224, a225 offset0:0 offset1:100
    ds_write2_b32 v68, a226, a227 offset0:0 offset1:100
    ds_write2_b32 v69, a228, a229 offset0:0 offset1:100
    ds_write2_b32 v70, a230, a231 offset0:0 offset1:100
    s_nop 2
    ds_write2_b32 v71, a232, a233 offset0:0 offset1:2
    ds_write2_b32 v71, a234, a235 offset0:4 offset1:6
    s_add_u32 m0, s66, 98304
    s_add_u32 s77, s77, 32768
    buffer_load_dwordx4 v25, s[44:47], s77 offen offset:0 lds
    buffer_load_dwordx4 v26, s[44:47], s77 offen offset:1024 lds
    buffer_load_dwordx4 v27, s[44:47], s77 offen offset:2048 lds
    buffer_load_dwordx4 v28, s[44:47], s77 offen offset:3072 lds
    s_waitcnt lgkmcnt(0)
    s_barrier
    ds_read2st64_b32 v[162:163], v58 offset0:17 offset1:81
    ds_read2st64_b32 v[164:165], v58 offset0:49 offset1:113
    ds_read2st64_b32 v[166:167], v59 offset0:17 offset1:81
    ds_read2st64_b32 v[168:169], v59 offset0:49 offset1:113
    ds_read2st64_b32 v[170:171], v60 offset0:17 offset1:81
    ds_read2st64_b32 v[172:173], v60 offset0:49 offset1:113
    ds_read2st64_b32 v[174:175], v61 offset0:17 offset1:81
    ds_read2st64_b32 v[176:177], v61 offset0:49 offset1:113
    ds_read2st64_b32 v[178:179], v62 offset0:17 offset1:81
    ds_read2st64_b32 v[180:181], v62 offset0:49 offset1:113
    ds_read2st64_b32 v[182:183], v63 offset0:17 offset1:81
    ds_read2st64_b32 v[184:185], v63 offset0:49 offset1:113
    ds_read2st64_b32 v[186:187], v64 offset0:17 offset1:81
    ds_read2st64_b32 v[188:189], v64 offset0:49 offset1:113
    ds_read2st64_b32 v[190:191], v65 offset0:17 offset1:81
    ds_read2st64_b32 v[192:193], v65 offset0:49 offset1:113
    ds_read2st64_b32 v[194:195], v66 offset0:17 offset1:81
    ds_read2st64_b32 v[196:197], v66 offset0:49 offset1:113
    s_add_u32 m0, s78, 32768
    s_add_u32 s77, s77, 32768
    buffer_load_dwordx4 v25, s[44:47], s77 offen offset:0 lds
    buffer_load_dwordx4 v26, s[44:47], s77 offen offset:1024 lds
    buffer_load_dwordx4 v27, s[44:47], s77 offen offset:2048 lds
    buffer_load_dwordx4 v28, s[44:47], s77 offen offset:3072 lds
    s_waitcnt lgkmcnt(15)
    v_pk_add_f32 v[162:163], v[162:163], v[164:165]
    s_waitcnt lgkmcnt(14)
    v_pk_add_f32 v[166:167], v[166:167], v[168:169]
    s_waitcnt lgkmcnt(12)
    v_pk_add_f32 v[170:171], v[170:171], v[172:173]
    s_waitcnt lgkmcnt(10)
    v_pk_add_f32 v[174:175], v[174:175], v[176:177]
    s_waitcnt lgkmcnt(8)
    v_pk_add_f32 v[178:179], v[178:179], v[180:181]
    s_waitcnt lgkmcnt(6)
    v_pk_add_f32 v[182:183], v[182:183], v[184:185]
    s_waitcnt lgkmcnt(4)
    v_pk_add_f32 v[186:187], v[186:187], v[188:189]
    s_waitcnt lgkmcnt(2)
    v_pk_add_f32 v[190:191], v[190:191], v[192:193]
    s_waitcnt lgkmcnt(0)
    v_pk_add_f32 v[194:195], v[194:195], v[196:197]
    v_cvt_pk_bf16_f32 v202, v162, v166
    v_cvt_pk_bf16_f32 v203, v170, v174
    v_cvt_pk_bf16_f32 v204, v178, v182
    v_cvt_pk_bf16_f32 v205, v186, v190
    v_cvt_pk_bf16_f32 v198, v166, v170
    v_cvt_pk_bf16_f32 v199, v174, v178
    v_cvt_pk_bf16_f32 v200, v182, v186
    v_cvt_pk_bf16_f32 v201, v190, v194
    v_cvt_pk_bf16_f32 v210, v163, v167
    v_cvt_pk_bf16_f32 v211, v171, v175
    v_cvt_pk_bf16_f32 v212, v179, v183
    v_cvt_pk_bf16_f32 v213, v187, v191
    v_cvt_pk_bf16_f32 v206, v167, v171
    v_cvt_pk_bf16_f32 v207, v175, v179
    v_cvt_pk_bf16_f32 v208, v183, v187
    v_cvt_pk_bf16_f32 v209, v191, v195
    ds_write_b128 v73, v[202:205] offset:8320
    ds_write_b128 v73, v[198:201] offset:0
    ds_write_b128 v73, v[210:213] offset:24704
    ds_write_b128 v73, v[206:209] offset:16384
    ds_write_b128 v74, v[16:19] offset:4096
    s_add_u32 m0, s78, 36864
    s_add_u32 s77, s77, 32768
    buffer_load_dwordx4 v25, s[44:47], s77 offen offset:0 lds
    buffer_load_dwordx4 v26, s[44:47], s77 offen offset:1024 lds
    buffer_load_dwordx4 v27, s[44:47], s77 offen offset:2048 lds
    buffer_load_dwordx4 v28, s[44:47], s77 offen offset:3072 lds
    s_add_u32 m0, s66, 114688
    s_add_u32 s77, s77, 32768
    buffer_load_dwordx4 v25, s[44:47], s77 offen offset:0 lds
    buffer_load_dwordx4 v26, s[44:47], s77 offen offset:1024 lds
    buffer_load_dwordx4 v27, s[44:47], s77 offen offset:2048 lds
    buffer_load_dwordx4 v28, s[44:47], s77 offen offset:3072 lds
    s_add_u32 m0, s66, 65536
    s_add_u32 s77, s77, 32768
    buffer_load_dwordx4 v25, s[44:47], s77 offen offset:0 lds
    buffer_load_dwordx4 v26, s[44:47], s77 offen offset:1024 lds
    buffer_load_dwordx4 v27, s[44:47], s77 offen offset:2048 lds
    buffer_load_dwordx4 v28, s[44:47], s77 offen offset:3072 lds
    s_add_u32 m0, s66, 131072
    s_add_u32 s77, s77, 32768
    buffer_load_dwordx4 v25, s[44:47], s77 offen offset:0 lds
    buffer_load_dwordx4 v26, s[44:47], s77 offen offset:1024 lds
    buffer_load_dwordx4 v27, s[44:47], s77 offen offset:2048 lds
    buffer_load_dwordx4 v28, s[44:47], s77 offen offset:3072 lds
    buffer_load_dword v7, v24, s[48:51], s13 offen sc1
    s_waitcnt vmcnt(21)
    ds_read_b64_tr_b16 a[0:1], v29 offset:32768
    ds_read_b64_tr_b16 a[2:3], v29 offset:34816
    ds_read_b64_tr_b16 a[4:5], v30 offset:32768
    ds_read_b64_tr_b16 a[6:7], v30 offset:34816
    ds_read_b64_tr_b16 a[8:9], v31 offset:32768
    ds_read_b64_tr_b16 a[10:11], v31 offset:34816
    ds_read_b64_tr_b16 a[12:13], v32 offset:32768
    ds_read_b64_tr_b16 a[14:15], v32 offset:34816
    s_waitcnt vmcnt(17)
    ds_read_b64_tr_b16 a[16:17], v33 offset:0
    ds_read_b64_tr_b16 a[18:19], v33 offset:2048
    ds_read_b64_tr_b16 a[20:21], v34 offset:0
    ds_read_b64_tr_b16 a[22:23], v34 offset:2048
    ds_read_b64_tr_b16 a[24:25], v35 offset:0
    ds_read_b64_tr_b16 a[26:27], v35 offset:2048
    ds_read_b64_tr_b16 a[28:29], v36 offset:0
    ds_read_b64_tr_b16 a[30:31], v36 offset:2048
    s_waitcnt vmcnt(13)
    ds_read_b64_tr_b16 a[32:33], v33 offset:4096
    ds_read_b64_tr_b16 a[34:35], v33 offset:6144
    ds_read_b64_tr_b16 a[36:37], v34 offset:4096
    ds_read_b64_tr_b16 a[38:39], v34 offset:6144
    ds_read_b64_tr_b16 a[40:41], v35 offset:4096
    ds_read_b64_tr_b16 a[42:43], v35 offset:6144
    ds_read_b64_tr_b16 a[44:45], v36 offset:4096
    ds_read_b64_tr_b16 a[46:47], v36 offset:6144
    ds_write_b64 v39, v[16:17] offset:32768
    v_add_u32 v33, 65536, v29
    v_add_u32 v34, 65536, v30
    v_add_u32 v35, 65536, v31
    v_add_u32 v36, 65536, v32
    s_waitcnt vmcnt(0)
    v_cmp_ne_u32 vcc, s64, v7
    s_cbranch_vccnz Lretry6
Lback6:
    s_waitcnt lgkmcnt(1)
    s_add_u32 m0, s5, 33280
    s_nop 0
    buffer_load_dwordx4 v20, s[48:51], s4 offen offset:0 sc1 lds
    buffer_load_dwordx4 v20, s[48:51], s4 offen offset:1024 sc1 lds
    buffer_load_dwordx4 v20, s[48:51], s4 offen offset:2048 sc1 lds
    buffer_load_dwordx4 v20, s[48:51], s4 offen offset:3072 sc1 lds
    s_add_u32 m0, s66, 81920
    s_add_u32 s77, s77, 32768
    buffer_load_dwordx4 v25, s[44:47], s77 offen offset:0 lds
    buffer_load_dwordx4 v26, s[44:47], s77 offen offset:1024 lds
    buffer_load_dwordx4 v27, s[44:47], s77 offen offset:2048 lds
    buffer_load_dwordx4 v28, s[44:47], s77 offen offset:3072 lds
    s_add_u32 m0, s66, 147456
    s_add_u32 s77, s77, 32768
    buffer_load_dwordx4 v25, s[44:47], s77 offen offset:0 lds
    buffer_load_dwordx4 v26, s[44:47], s77 offen offset:1024 lds
    buffer_load_dwordx4 v27, s[44:47], s77 offen offset:2048 lds
    buffer_load_dwordx4 v28, s[44:47], s77 offen offset:3072 lds
    s_waitcnt vmcnt(8)
    s_branch Ljoin
Lcode_end:
    s_endpgm
.section .rodata,"a"
.p2align 6
.amdhsa_kernel gated_mix__ssm_conv_s4d__mixer_channel_mlp__prompt_kernel
  .amdhsa_next_free_vgpr 512
  .amdhsa_next_free_sgpr 102
  .amdhsa_accum_offset 256
  .amdhsa_group_segment_fixed_size 0
  .amdhsa_kernarg_size 128
  .amdhsa_user_sgpr_count 2
  .amdhsa_user_sgpr_kernarg_segment_ptr 1
  .amdhsa_system_sgpr_workgroup_id_x 1
.end_amdhsa_kernel
```
